```python
import torch

def _softmax(x, axis=-1):
    return torch.softmax(x, dim=axis)
def _gelu(x):
    return torch.nn.functional.gelu(x, approximate="tanh")
def _silu(x):
    return torch.nn.functional.silu(x)
def _sigmoid(x):
    return torch.sigmoid(x)
def _layernorm(x, axis=-1, eps=1e-5):
    m = x.mean(dim=axis, keepdim=True)
    v = x.var(dim=axis, keepdim=True, unbiased=False)
    return (x - m) / torch.sqrt(v + eps)
def _scatter_add(tgt, idx, src, axis=0):
    return tgt.clone().index_add_(axis, idx, src)
def _segment_sum(src, seg, n):
    out = torch.zeros((n,) + src.shape[1:], dtype=src.dtype)
    return out.index_add_(0, seg, src)
def _pad(x, pw):
    flat = tuple(v for pair in reversed(pw) for v in pair)
    return torch.nn.functional.pad(x, flat)

kernel_name = 'standalone__mha_block_cached__near_ridge'

def setup_inputs():

    _w = (lambda a: (lambda t: t.to(torch.bfloat16) if t.is_floating_point() else t)(torch.as_tensor(a)))
    B, Sq, D = 8, 128, 1024
    H, Sk, Dh = 32, 512, 128
    return {
        "x": _w((lambda *s: torch.randn(*s, dtype=torch.bfloat16) * 0.8)(B, Sq, D)),
        "k_cache": _w((lambda *s: torch.randn(*s, dtype=torch.bfloat16) * 0.8)(B, H, Sk, Dh)),
        "v_cache": _w((lambda *s: torch.randn(*s, dtype=torch.bfloat16) * 0.05)(B, H, Sk, Dh)),
        "wq": _w((lambda *s: torch.randn(*s, dtype=torch.bfloat16) * 0.8)(D, H * Dh) * (D ** -0.5)),
        "wo": _w((lambda *s: torch.randn(*s, dtype=torch.bfloat16) * 0.05)(H * Dh, D) * ((H * Dh) ** -0.5)),
    }

def reference(x, k_cache, v_cache, wq, wo):
    B, Sq, D = x.shape
    H, Dh = 32, 128
    q = (lambda x, *d: x.permute(*d))((x @ wq).reshape(B, Sq, H, Dh), 0, 2, 1, 3)
    scores = torch.einsum("bhqd,bhkd->bhqk", q, k_cache) * (Dh ** -0.5)
    p = _softmax(scores, axis=-1)
    o = torch.einsum("bhqk,bhkd->bhqd", p, v_cache)
    return (lambda x, *d: x.permute(*d))(o, 0, 2, 1, 3).reshape(B, Sq, H * Dh) @ wo
```

```asm
; @launch grid=(256,1,1) block=(256,1,1) lds=163840
.amdgcn_target "amdgcn-amd-amdhsa--gfx950"
.text
.globl standalone__mha_block_cached__near_ridge_kernel
.p2align 8
.type standalone__mha_block_cached__near_ridge_kernel,@function
standalone__mha_block_cached__near_ridge_kernel:
    s_cmp_ge_u32 s2, 256
    s_cbranch_scc1 L_end
    s_load_dwordx8 s[36:43], s[0:1], 0
    s_load_dwordx8 s[88:95], s[0:1], 32
    s_getpc_b64 s[46:47]
L_pc:
    s_lshr_b32 s34, s2, 3
    s_lshl_b32 s34, s34, 12
    v_lshlrev_b32 v136, 4, v0
    v_add_u32 v136, s34, v136
    v_and_b32 v136, 0x7fff, v136
    s_mov_b32 s35, L_code_end-L_pc-16
    v_cmp_gt_u32 vcc, s35, v136
    s_nop 3
    s_and_saveexec_b64 s[34:35], vcc
    s_cbranch_execz L_pfc_done
    global_load_dwordx4 v[140:143], v136, s[46:47]
L_pfc_done:
    s_mov_b64 exec, s[34:35]
    v_lshrrev_b32 v1, 6, v0
    v_and_b32 v30, 63, v0
    s_nop 0
    v_readfirstlane_b32 s24, v1
    s_and_b32 s3, s2, 7
    s_lshr_b32 s34, s2, 3
    s_and_b32 s56, s34, 3
    s_lshr_b32 s57, s34, 2
    s_lshr_b32 s58, s3, 1
    s_and_b32 s25, s3, 1
    s_lshl_b32 s25, s25, 2
    s_add_u32 s25, s25, s56
    s_lshl_b32 s26, s58, 3
    s_add_u32 s26, s26, s57
    s_lshl_b32 s27, s56, 2
    s_lshl_b32 s46, s57, 1
    s_add_u32 s27, s27, s46
    s_and_b32 s27, s27, 15
    v_lshrrev_b32 v128, 3, v30
    v_mov_b32 v131, s24
    v_lshl_add_u32 v128, v131, 5, v128
    v_lshlrev_b32 v128, 11, v128
    v_lshrrev_b32 v129, 4, v30
    v_and_b32 v130, 7, v30
    v_xor_b32 v130, v130, v129
    v_xor_b32 v1, 0, v130
    v_lshl_add_u32 v1, v1, 4, v128
    v_xor_b32 v2, 4, v130
    v_lshl_add_u32 v2, v2, 4, v128
    v_add_u32 v2, 15360, v2
    v_xor_b32 v3, 0, v130
    v_lshl_add_u32 v3, v3, 4, v128
    v_add_u32 v3, 30720, v3
    v_xor_b32 v4, 4, v130
    v_lshl_add_u32 v4, v4, 4, v128
    v_add_u32 v4, 46080, v4
    v_and_b32 v128, 15, v30
    v_lshlrev_b32 v130, 2, v129
    v_xor_b32 v130, v130, v128
    v_lshlrev_b32 v130, 4, v130
    v_lshl_add_u32 v29, v129, 8, v130
    v_lshl_add_u32 v131, v131, 4, v129
    v_lshl_add_u32 v5, v131, 13, v130
    v_add_u32 v6, 31744, v5
    v_add_u32 v7, 63488, v5
    v_add_u32 v8, 95232, v5
    s_waitcnt lgkmcnt(0)
    s_lshl_b32 s46, s25, 18
    s_add_u32 s4, s36, s46
    s_addc_u32 s5, s37, 0
    s_and_b32 s5, s5, 0xffff
    s_mov_b32 s6, 262144
    s_mov_b32 s7, 0x20000
    s_lshl_b32 s46, s26, 8
    s_add_u32 s8, s42, s46
    s_addc_u32 s9, s43, 0
    s_and_b32 s9, s9, 0xffff
    s_mov_b32 s10, 0
    s_mov_b32 s11, 0x20000
    s_sub_u32 s10, 8388608, s46
    s_lshl_b32 s31, s24, 12
    s_lshl_b32 s32, s27, 7
    s_lshl_b32 s33, s27, 19
    s_add_u32 m0, s31, 65536
    s_nop 0
    buffer_load_dwordx4 v1, s[4:7], s32 offen  lds
    buffer_load_dwordx4 v2, s[4:7], s32 offen offset:1024  lds
    buffer_load_dwordx4 v3, s[4:7], s32 offen offset:2048  lds
    buffer_load_dwordx4 v4, s[4:7], s32 offen offset:3072  lds
    s_add_u32 m0, s31, 81920
    s_nop 0
    buffer_load_dwordx4 v5, s[8:11], s33 offen  lds
    buffer_load_dwordx4 v6, s[8:11], s33 offen offset:1024  lds
    buffer_load_dwordx4 v7, s[8:11], s33 offen offset:2048  lds
    buffer_load_dwordx4 v8, s[8:11], s33 offen offset:3072  lds
    s_add_u32 s32, s32, 128
    s_and_b32 s32, s32, 0x7ff
    s_add_u32 s33, s33, 0x80000
    s_and_b32 s33, s33, 0x7fffff
    v_and_b32 v128, 15, v30
    v_add_u32 v130, 0, v129
    v_xor_b32 v130, v130, v128
    v_lshlrev_b32 v130, 4, v130
    v_lshl_add_u32 v25, v129, 8, v130
    v_add_u32 v130, 4, v129
    v_xor_b32 v130, v130, v128
    v_lshlrev_b32 v130, 4, v130
    v_lshl_add_u32 v26, v129, 8, v130
    v_add_u32 v130, 8, v129
    v_xor_b32 v130, v130, v128
    v_lshlrev_b32 v130, 4, v130
    v_lshl_add_u32 v27, v129, 8, v130
    v_add_u32 v130, 12, v129
    v_xor_b32 v130, v130, v128
    v_lshlrev_b32 v130, 4, v130
    v_lshl_add_u32 v28, v129, 8, v130
    v_and_b32 v128, 31, v30
    v_lshrrev_b32 v129, 5, v30
    v_bfe_u32 v130, v30, 1, 3
    v_xor_b32 v130, v130, v129
    v_lshlrev_b32 v130, 4, v130
    v_mov_b32 v131, s24
    v_lshl_add_u32 v131, v131, 5, v128
    v_lshl_add_u32 v9, v131, 7, v130
    v_xor_b32 v10, 32, v9
    v_xor_b32 v11, 64, v9
    v_xor_b32 v12, 96, v9
    v_and_b32 v130, 0x13, v128
    v_bfe_u32 v131, v128, 2, 1
    v_lshl_add_u32 v130, v131, 3, v130
    v_bfe_u32 v131, v128, 3, 1
    v_lshl_add_u32 v130, v131, 2, v130
    v_and_b32 v131, 15, v130
    v_xor_b32 v131, v131, v129
    v_lshlrev_b32 v131, 4, v131
    v_lshl_add_u32 v17, v130, 8, v131
    s_and_b32 s46, s24, 1
    s_lshl_b32 s46, s46, 7
    v_xor_b32 v17, s46, v17
    v_xor_b32 v18, 32, v17
    v_xor_b32 v19, 64, v17
    v_xor_b32 v20, 96, v17
    v_xor_b32 v21, 128, v17
    v_xor_b32 v22, 160, v17
    v_xor_b32 v23, 192, v17
    v_xor_b32 v24, 224, v17
    v_lshrrev_b32 v128, 5, v30
    v_lshlrev_b32 v128, 11, v128
    v_bfe_u32 v129, v30, 2, 2
    v_lshl_add_u32 v128, v129, 8, v128
    v_lshl_add_u32 v128, v129, 6, v128
    v_bfe_u32 v130, v30, 4, 1
    v_lshl_add_u32 v128, v130, 5, v128
    v_and_b32 v130, 1, v30
    v_lshl_add_u32 v128, v130, 4, v128
    v_bfe_u32 v130, v30, 1, 1
    v_lshl_add_u32 v13, v130, 3, v128
    v_xor_b32 v14, 64, v13
    v_xor_b32 v15, 128, v13
    v_xor_b32 v16, 192, v13
    s_lshl_b32 s46, s25, 5
    s_add_u32 s46, s46, s26
    s_lshl_b32 s46, s46, 17
    s_add_u32 s12, s38, s46
    s_addc_u32 s13, s39, 0
    s_and_b32 s13, s13, 0xffff
    s_mov_b32 s14, 131072
    s_mov_b32 s15, 0x20000
    s_add_u32 s16, s40, s46
    s_addc_u32 s17, s41, 0
    s_and_b32 s17, s17, 0xffff
    s_mov_b32 s18, 131072
    s_mov_b32 s19, 0x20000
    s_lshl_b32 s46, s25, 2
    s_add_u32 s46, s46, s24
    s_lshl_b32 s46, s46, 8
    s_lshl_b32 s47, s26, 3
    s_add_u32 s46, s46, s47
    s_lshl_b32 s46, s46, 10
    s_add_u32 s46, s46, 0
    s_add_u32 s20, s94, s46
    s_addc_u32 s21, s95, 0
    s_and_b32 s21, s21, 0xffff
    s_mov_b32 s22, 8192
    s_mov_b32 s23, 0x20000
    v_xor_b32 v32, 4096, v9
    v_add_u32 v36, 65536, v9
    v_add_u32 v40, 65536, v32
    v_xor_b32 v33, 4096, v10
    v_add_u32 v37, 65536, v10
    v_add_u32 v41, 65536, v33
    v_xor_b32 v34, 4096, v11
    v_add_u32 v38, 65536, v11
    v_add_u32 v42, 65536, v34
    v_xor_b32 v35, 4096, v12
    v_add_u32 v39, 65536, v12
    v_add_u32 v43, 65536, v35
    s_and_b32 s46, s24, 1
    s_lshl_b32 s46, s46, 7
    v_xor_b32 v44, s46, v13
    v_xor_b32 v45, 64, v44
    v_add_u32 v46, 65536, v44
    v_add_u32 v47, 65536, v45
    v_mov_b32 v64, 0
    v_mov_b32 v65, 0
    v_mov_b32 v66, 0
    v_mov_b32 v67, 0
    v_mov_b32 v68, 0
    v_mov_b32 v69, 0
    v_mov_b32 v70, 0
    v_mov_b32 v71, 0
    v_mov_b32 v72, 0
    v_mov_b32 v73, 0
    v_mov_b32 v74, 0
    v_mov_b32 v75, 0
    v_mov_b32 v76, 0
    v_mov_b32 v77, 0
    v_mov_b32 v78, 0
    v_mov_b32 v79, 0
    v_mov_b32 v80, 0
    v_mov_b32 v81, 0
    v_mov_b32 v82, 0
    v_mov_b32 v83, 0
    v_mov_b32 v84, 0
    v_mov_b32 v85, 0
    v_mov_b32 v86, 0
    v_mov_b32 v87, 0
    v_mov_b32 v88, 0
    v_mov_b32 v89, 0
    v_mov_b32 v90, 0
    v_mov_b32 v91, 0
    v_mov_b32 v92, 0
    v_mov_b32 v93, 0
    v_mov_b32 v94, 0
    v_mov_b32 v95, 0
    v_mov_b32 v96, 0
    v_mov_b32 v97, 0
    v_mov_b32 v98, 0
    v_mov_b32 v99, 0
    v_mov_b32 v100, 0
    v_mov_b32 v101, 0
    v_mov_b32 v102, 0
    v_mov_b32 v103, 0
    v_mov_b32 v104, 0
    v_mov_b32 v105, 0
    v_mov_b32 v106, 0
    v_mov_b32 v107, 0
    v_mov_b32 v108, 0
    v_mov_b32 v109, 0
    v_mov_b32 v110, 0
    v_mov_b32 v111, 0
    v_mov_b32 v112, 0
    v_mov_b32 v113, 0
    v_mov_b32 v114, 0
    v_mov_b32 v115, 0
    v_mov_b32 v116, 0
    v_mov_b32 v117, 0
    v_mov_b32 v118, 0
    v_mov_b32 v119, 0
    v_mov_b32 v120, 0
    v_mov_b32 v121, 0
    v_mov_b32 v122, 0
    v_mov_b32 v123, 0
    v_mov_b32 v124, 0
    v_mov_b32 v125, 0
    v_mov_b32 v126, 0
    v_mov_b32 v127, 0
    v_accvgpr_write_b32 a32, 0
    v_accvgpr_write_b32 a33, 0
    v_accvgpr_write_b32 a34, 0
    v_accvgpr_write_b32 a35, 0
    v_accvgpr_write_b32 a36, 0
    v_accvgpr_write_b32 a37, 0
    v_accvgpr_write_b32 a38, 0
    v_accvgpr_write_b32 a39, 0
    v_accvgpr_write_b32 a40, 0
    v_accvgpr_write_b32 a41, 0
    v_accvgpr_write_b32 a42, 0
    v_accvgpr_write_b32 a43, 0
    v_accvgpr_write_b32 a44, 0
    v_accvgpr_write_b32 a45, 0
    v_accvgpr_write_b32 a46, 0
    v_accvgpr_write_b32 a47, 0
    v_accvgpr_write_b32 a48, 0
    v_accvgpr_write_b32 a49, 0
    v_accvgpr_write_b32 a50, 0
    v_accvgpr_write_b32 a51, 0
    v_accvgpr_write_b32 a52, 0
    v_accvgpr_write_b32 a53, 0
    v_accvgpr_write_b32 a54, 0
    v_accvgpr_write_b32 a55, 0
    v_accvgpr_write_b32 a56, 0
    v_accvgpr_write_b32 a57, 0
    v_accvgpr_write_b32 a58, 0
    v_accvgpr_write_b32 a59, 0
    v_accvgpr_write_b32 a60, 0
    v_accvgpr_write_b32 a61, 0
    v_accvgpr_write_b32 a62, 0
    v_accvgpr_write_b32 a63, 0
    s_add_u32 m0, s31, 0
    s_nop 0
    buffer_load_dwordx4 v1, s[4:7], s32 offen  lds
    buffer_load_dwordx4 v2, s[4:7], s32 offen offset:1024  lds
    buffer_load_dwordx4 v3, s[4:7], s32 offen offset:2048  lds
    buffer_load_dwordx4 v4, s[4:7], s32 offen offset:3072  lds
    s_add_u32 m0, s31, 16384
    s_nop 0
    buffer_load_dwordx4 v5, s[8:11], s33 offen  lds
    buffer_load_dwordx4 v6, s[8:11], s33 offen offset:1024  lds
    buffer_load_dwordx4 v7, s[8:11], s33 offen offset:2048  lds
    buffer_load_dwordx4 v8, s[8:11], s33 offen offset:3072  lds
    s_add_u32 s32, s32, 128
    s_and_b32 s32, s32, 0x7ff
    s_add_u32 s33, s33, 0x80000
    s_and_b32 s33, s33, 0x7fffff
    v_mov_b32 v132, 50364416
    s_or_b32 s46, s2, s24
    s_cmp_lg_u32 s46, 0
    s_cbranch_scc1 L_noepoch
    global_load_dwordx2 v[134:135], v132, s[94:95] sc1
L_noepoch:
    s_mov_b32 s30, 0
    s_mov_b32 s29, 0
    s_mov_b32 s50, 98304
    s_mov_b32 s51, 0
    s_mov_b32 s28, 6
    s_bitcmp1_b32 s57, 0
    s_cselect_b32 s28, 6, 12
    s_waitcnt vmcnt(8)
    s_barrier
L_q:
    v_mfma_f32_32x32x16_bf16 v[64:79], a[40:43], a[32:35], v[64:79]
    ds_read_b128 a[0:3], v36 offset:0
    ds_read_b64_tr_b16 a[8:9], v46 offset:16384
    v_mfma_f32_32x32x16_bf16 v[96:111], a[40:43], a[36:39], v[96:111]
    s_add_u32 m0, s31, 32768
    ds_read_b64_tr_b16 a[10:11], v46 offset:17408
    ds_read_b128 a[4:7], v40 offset:0
    buffer_load_dwordx4 v1, s[4:7], s32 offen  lds
    v_mfma_f32_32x32x16_bf16 v[80:95], a[44:47], a[32:35], v[80:95]
    ds_read_b64_tr_b16 a[12:13], v47 offset:16384
    ds_read_b64_tr_b16 a[14:15], v47 offset:17408
    v_mfma_f32_32x32x16_bf16 v[112:127], a[44:47], a[36:39], v[112:127]
    ds_read_b128 a[16:19], v37 offset:0
    ds_read_b64_tr_b16 a[24:25], v46 offset:20480
    buffer_load_dwordx4 v2, s[4:7], s32 offen offset:1024  lds
    v_mfma_f32_32x32x16_bf16 v[64:79], a[56:59], a[48:51], v[64:79]
    ds_read_b64_tr_b16 a[26:27], v46 offset:21504
    ds_read_b128 a[20:23], v41 offset:0
    v_mfma_f32_32x32x16_bf16 v[96:111], a[56:59], a[52:55], v[96:111]
    ds_read_b64_tr_b16 a[28:29], v47 offset:20480
    ds_read_b64_tr_b16 a[30:31], v47 offset:21504
    buffer_load_dwordx4 v3, s[4:7], s32 offen offset:2048  lds
    v_mfma_f32_32x32x16_bf16 v[80:95], a[60:63], a[48:51], v[80:95]
    ds_read_b128 a[32:35], v38 offset:0
    ds_read_b64_tr_b16 a[40:41], v46 offset:24576
    v_mfma_f32_32x32x16_bf16 v[112:127], a[60:63], a[52:55], v[112:127]
    ds_read_b64_tr_b16 a[42:43], v46 offset:25600
    ds_read_b128 a[36:39], v42 offset:0
    buffer_load_dwordx4 v4, s[4:7], s32 offen offset:3072  lds
    s_waitcnt lgkmcnt(10)
    v_mfma_f32_32x32x16_bf16 v[64:79], a[8:11], a[0:3], v[64:79]
    ds_read_b64_tr_b16 a[44:45], v47 offset:24576
    ds_read_b64_tr_b16 a[46:47], v47 offset:25600
    v_mfma_f32_32x32x16_bf16 v[96:111], a[8:11], a[4:7], v[96:111]
    s_add_u32 m0, s31, 49152
    ds_read_b128 a[48:51], v39 offset:0
    ds_read_b64_tr_b16 a[56:57], v46 offset:28672
    buffer_load_dwordx4 v5, s[8:11], s33 offen  lds
    v_mfma_f32_32x32x16_bf16 v[80:95], a[12:15], a[0:3], v[80:95]
    ds_read_b64_tr_b16 a[58:59], v46 offset:29696
    ds_read_b128 a[52:55], v43 offset:0
    v_mfma_f32_32x32x16_bf16 v[112:127], a[12:15], a[4:7], v[112:127]
    ds_read_b64_tr_b16 a[60:61], v47 offset:28672
    ds_read_b64_tr_b16 a[62:63], v47 offset:29696
    buffer_load_dwordx4 v6, s[8:11], s33 offen offset:1024  lds
    s_waitcnt lgkmcnt(12)
    v_mfma_f32_32x32x16_bf16 v[64:79], a[24:27], a[16:19], v[64:79]
    v_mfma_f32_32x32x16_bf16 v[96:111], a[24:27], a[20:23], v[96:111]
    buffer_load_dwordx4 v7, s[8:11], s33 offen offset:2048  lds
    v_mfma_f32_32x32x16_bf16 v[80:95], a[28:31], a[16:19], v[80:95]
    v_mfma_f32_32x32x16_bf16 v[112:127], a[28:31], a[20:23], v[112:127]
    buffer_load_dwordx4 v8, s[8:11], s33 offen offset:3072  lds
    s_add_u32 s32, s32, 128
    s_and_b32 s32, s32, 0x7ff
    s_add_u32 s33, s33, 0x80000
    s_and_b32 s33, s33, 0x7fffff
    s_cmp_lg_u32 s29, 0
    s_waitcnt vmcnt(16) lgkmcnt(0)
    s_cbranch_scc1 L_qw1
    s_waitcnt vmcnt(8)
L_qw1:
    s_barrier
    v_mfma_f32_32x32x16_bf16 v[64:79], a[40:43], a[32:35], v[64:79]
    ds_read_b128 a[0:3], v9 offset:0
    ds_read_b64_tr_b16 a[8:9], v44 offset:16384
    v_mfma_f32_32x32x16_bf16 v[96:111], a[40:43], a[36:39], v[96:111]
    s_add_u32 m0, s31, 65536
    ds_read_b64_tr_b16 a[10:11], v44 offset:17408
    ds_read_b128 a[4:7], v32 offset:0
    buffer_load_dwordx4 v1, s[4:7], s32 offen  lds
    v_mfma_f32_32x32x16_bf16 v[80:95], a[44:47], a[32:35], v[80:95]
    ds_read_b64_tr_b16 a[12:13], v45 offset:16384
    ds_read_b64_tr_b16 a[14:15], v45 offset:17408
    v_mfma_f32_32x32x16_bf16 v[112:127], a[44:47], a[36:39], v[112:127]
    ds_read_b128 a[16:19], v10 offset:0
    ds_read_b64_tr_b16 a[24:25], v44 offset:20480
    buffer_load_dwordx4 v2, s[4:7], s32 offen offset:1024  lds
    v_mfma_f32_32x32x16_bf16 v[64:79], a[56:59], a[48:51], v[64:79]
    ds_read_b64_tr_b16 a[26:27], v44 offset:21504
    ds_read_b128 a[20:23], v33 offset:0
    v_mfma_f32_32x32x16_bf16 v[96:111], a[56:59], a[52:55], v[96:111]
    ds_read_b64_tr_b16 a[28:29], v45 offset:20480
    ds_read_b64_tr_b16 a[30:31], v45 offset:21504
    buffer_load_dwordx4 v3, s[4:7], s32 offen offset:2048  lds
    v_mfma_f32_32x32x16_bf16 v[80:95], a[60:63], a[48:51], v[80:95]
    ds_read_b128 a[32:35], v11 offset:0
    ds_read_b64_tr_b16 a[40:41], v44 offset:24576
    v_mfma_f32_32x32x16_bf16 v[112:127], a[60:63], a[52:55], v[112:127]
    ds_read_b64_tr_b16 a[42:43], v44 offset:25600
    ds_read_b128 a[36:39], v34 offset:0
    buffer_load_dwordx4 v4, s[4:7], s32 offen offset:3072  lds
    s_waitcnt lgkmcnt(10)
    v_mfma_f32_32x32x16_bf16 v[64:79], a[8:11], a[0:3], v[64:79]
    ds_read_b64_tr_b16 a[44:45], v45 offset:24576
    ds_read_b64_tr_b16 a[46:47], v45 offset:25600
    v_mfma_f32_32x32x16_bf16 v[96:111], a[8:11], a[4:7], v[96:111]
    s_add_u32 m0, s31, 81920
    ds_read_b128 a[48:51], v12 offset:0
    ds_read_b64_tr_b16 a[56:57], v44 offset:28672
    buffer_load_dwordx4 v5, s[8:11], s33 offen  lds
    v_mfma_f32_32x32x16_bf16 v[80:95], a[12:15], a[0:3], v[80:95]
    ds_read_b64_tr_b16 a[58:59], v44 offset:29696
    ds_read_b128 a[52:55], v35 offset:0
    v_mfma_f32_32x32x16_bf16 v[112:127], a[12:15], a[4:7], v[112:127]
    ds_read_b64_tr_b16 a[60:61], v45 offset:28672
    ds_read_b64_tr_b16 a[62:63], v45 offset:29696
    buffer_load_dwordx4 v6, s[8:11], s33 offen offset:1024  lds
    s_waitcnt lgkmcnt(12)
    v_mfma_f32_32x32x16_bf16 v[64:79], a[24:27], a[16:19], v[64:79]
    v_mfma_f32_32x32x16_bf16 v[96:111], a[24:27], a[20:23], v[96:111]
    buffer_load_dwordx4 v7, s[8:11], s33 offen offset:2048  lds
    v_mfma_f32_32x32x16_bf16 v[80:95], a[28:31], a[16:19], v[80:95]
    v_mfma_f32_32x32x16_bf16 v[112:127], a[28:31], a[20:23], v[112:127]
    buffer_load_dwordx4 v8, s[8:11], s33 offen offset:3072  lds
    s_add_u32 s32, s32, 128
    s_and_b32 s32, s32, 0x7ff
    s_add_u32 s33, s33, 0x80000
    s_and_b32 s33, s33, 0x7fffff
    s_waitcnt vmcnt(8) lgkmcnt(0)
    s_barrier
    v_mfma_f32_32x32x16_bf16 v[64:79], a[40:43], a[32:35], v[64:79]
    ds_read_b128 a[0:3], v9 offset:32768
    ds_read_b64_tr_b16 a[8:9], v44 offset:49152
    v_mfma_f32_32x32x16_bf16 v[96:111], a[40:43], a[36:39], v[96:111]
    s_add_u32 m0, s31, 0
    ds_read_b64_tr_b16 a[10:11], v44 offset:50176
    ds_read_b128 a[4:7], v32 offset:32768
    buffer_load_dwordx4 v1, s[4:7], s32 offen  lds
    v_mfma_f32_32x32x16_bf16 v[80:95], a[44:47], a[32:35], v[80:95]
    ds_read_b64_tr_b16 a[12:13], v45 offset:49152
    ds_read_b64_tr_b16 a[14:15], v45 offset:50176
    v_mfma_f32_32x32x16_bf16 v[112:127], a[44:47], a[36:39], v[112:127]
    ds_read_b128 a[16:19], v10 offset:32768
    ds_read_b64_tr_b16 a[24:25], v44 offset:53248
    buffer_load_dwordx4 v2, s[4:7], s32 offen offset:1024  lds
    v_mfma_f32_32x32x16_bf16 v[64:79], a[56:59], a[48:51], v[64:79]
    ds_read_b64_tr_b16 a[26:27], v44 offset:54272
    ds_read_b128 a[20:23], v33 offset:32768
    v_mfma_f32_32x32x16_bf16 v[96:111], a[56:59], a[52:55], v[96:111]
    ds_read_b64_tr_b16 a[28:29], v45 offset:53248
    ds_read_b64_tr_b16 a[30:31], v45 offset:54272
    buffer_load_dwordx4 v3, s[4:7], s32 offen offset:2048  lds
    v_mfma_f32_32x32x16_bf16 v[80:95], a[60:63], a[48:51], v[80:95]
    ds_read_b128 a[32:35], v11 offset:32768
    ds_read_b64_tr_b16 a[40:41], v44 offset:57344
    v_mfma_f32_32x32x16_bf16 v[112:127], a[60:63], a[52:55], v[112:127]
    ds_read_b64_tr_b16 a[42:43], v44 offset:58368
    ds_read_b128 a[36:39], v34 offset:32768
    buffer_load_dwordx4 v4, s[4:7], s32 offen offset:3072  lds
    s_waitcnt lgkmcnt(10)
    v_mfma_f32_32x32x16_bf16 v[64:79], a[8:11], a[0:3], v[64:79]
    ds_read_b64_tr_b16 a[44:45], v45 offset:57344
    ds_read_b64_tr_b16 a[46:47], v45 offset:58368
    v_mfma_f32_32x32x16_bf16 v[96:111], a[8:11], a[4:7], v[96:111]
    s_add_u32 m0, s31, 16384
    ds_read_b128 a[48:51], v12 offset:32768
    ds_read_b64_tr_b16 a[56:57], v44 offset:61440
    buffer_load_dwordx4 v5, s[8:11], s33 offen  lds
    v_mfma_f32_32x32x16_bf16 v[80:95], a[12:15], a[0:3], v[80:95]
    ds_read_b64_tr_b16 a[58:59], v44 offset:62464
    ds_read_b128 a[52:55], v35 offset:32768
    v_mfma_f32_32x32x16_bf16 v[112:127], a[12:15], a[4:7], v[112:127]
    ds_read_b64_tr_b16 a[60:61], v45 offset:61440
    ds_read_b64_tr_b16 a[62:63], v45 offset:62464
    buffer_load_dwordx4 v6, s[8:11], s33 offen offset:1024  lds
    s_waitcnt lgkmcnt(12)
    v_mfma_f32_32x32x16_bf16 v[64:79], a[24:27], a[16:19], v[64:79]
    v_mfma_f32_32x32x16_bf16 v[96:111], a[24:27], a[20:23], v[96:111]
    buffer_load_dwordx4 v7, s[8:11], s33 offen offset:2048  lds
    v_mfma_f32_32x32x16_bf16 v[80:95], a[28:31], a[16:19], v[80:95]
    v_mfma_f32_32x32x16_bf16 v[112:127], a[28:31], a[20:23], v[112:127]
    buffer_load_dwordx4 v8, s[8:11], s33 offen offset:3072  lds
    s_add_u32 s32, s32, 128
    s_and_b32 s32, s32, 0x7ff
    s_add_u32 s33, s33, 0x80000
    s_and_b32 s33, s33, 0x7fffff
    s_lshr_b32 s29, s28, s30
    s_and_b32 s29, s29, 1
    s_cbranch_scc0 L_noburst
    s_lshl_b32 s47, s24, 13
    s_add_u32 s47, s47, 0
    s_add_u32 m0, s50, s47
    s_add_u32 s47, s47, s51
    buffer_load_dwordx4 v25, s[12:15], s47 offen nt lds
    buffer_load_dwordx4 v26, s[12:15], s47 offen offset:1024 nt lds
    buffer_load_dwordx4 v27, s[12:15], s47 offen offset:2048 nt lds
    buffer_load_dwordx4 v28, s[12:15], s47 offen offset:3072 nt lds
    s_lshl_b32 s47, s24, 13
    s_add_u32 s47, s47, 4096
    s_add_u32 m0, s50, s47
    s_add_u32 s47, s47, s51
    buffer_load_dwordx4 v25, s[12:15], s47 offen nt lds
    buffer_load_dwordx4 v26, s[12:15], s47 offen offset:1024 nt lds
    buffer_load_dwordx4 v27, s[12:15], s47 offen offset:2048 nt lds
    buffer_load_dwordx4 v28, s[12:15], s47 offen offset:3072 nt lds
    s_add_u32 s50, s50, 32768
    s_add_u32 s51, s51, 32768
    s_getpc_b64 s[46:47]
L_pc3:
    s_add_u32 s46, s46, L_att0-L_pc3
    s_addc_u32 s47, s47, 0
    s_lshr_b32 s34, s2, 3
    s_lshl_b32 s34, s34, 12
    v_lshlrev_b32 v136, 4, v0
    v_add_u32 v136, s34, v136
    v_and_b32 v136, 0x3fff, v136
    s_mov_b32 s35, L_p2-L_att0-16
    v_cmp_gt_u32 vcc, s35, v136
    s_nop 3
    s_and_saveexec_b64 s[34:35], vcc
    s_cbranch_execz L_pfc3_done
    global_load_dwordx4 v[140:143], v136, s[46:47]
L_pfc3_done:
    s_mov_b64 exec, s[34:35]
L_noburst:
    s_cmp_lg_u32 s29, 0
    s_waitcnt vmcnt(16) lgkmcnt(0)
    s_cbranch_scc1 L_qw2
    s_waitcnt vmcnt(8)
L_qw2:
    s_barrier
    s_add_u32 s30, s30, 1
    s_cmp_lt_u32 s30, 4
    s_cbranch_scc1 L_q
    v_mfma_f32_32x32x16_bf16 v[64:79], a[40:43], a[32:35], v[64:79]
    ds_read_b128 a[0:3], v36 offset:0
    ds_read_b64_tr_b16 a[8:9], v46 offset:16384
    v_mfma_f32_32x32x16_bf16 v[96:111], a[40:43], a[36:39], v[96:111]
    s_add_u32 m0, s31, 32768
    ds_read_b64_tr_b16 a[10:11], v46 offset:17408
    ds_read_b128 a[4:7], v40 offset:0
    buffer_load_dwordx4 v1, s[4:7], s32 offen  lds
    v_mfma_f32_32x32x16_bf16 v[80:95], a[44:47], a[32:35], v[80:95]
    ds_read_b64_tr_b16 a[12:13], v47 offset:16384
    ds_read_b64_tr_b16 a[14:15], v47 offset:17408
    v_mfma_f32_32x32x16_bf16 v[112:127], a[44:47], a[36:39], v[112:127]
    ds_read_b128 a[16:19], v37 offset:0
    ds_read_b64_tr_b16 a[24:25], v46 offset:20480
    buffer_load_dwordx4 v2, s[4:7], s32 offen offset:1024  lds
    v_mfma_f32_32x32x16_bf16 v[64:79], a[56:59], a[48:51], v[64:79]
    ds_read_b64_tr_b16 a[26:27], v46 offset:21504
    ds_read_b128 a[20:23], v41 offset:0
    v_mfma_f32_32x32x16_bf16 v[96:111], a[56:59], a[52:55], v[96:111]
    ds_read_b64_tr_b16 a[28:29], v47 offset:20480
    ds_read_b64_tr_b16 a[30:31], v47 offset:21504
    buffer_load_dwordx4 v3, s[4:7], s32 offen offset:2048  lds
    v_mfma_f32_32x32x16_bf16 v[80:95], a[60:63], a[48:51], v[80:95]
    ds_read_b128 a[32:35], v38 offset:0
    ds_read_b64_tr_b16 a[40:41], v46 offset:24576
    v_mfma_f32_32x32x16_bf16 v[112:127], a[60:63], a[52:55], v[112:127]
    ds_read_b64_tr_b16 a[42:43], v46 offset:25600
    ds_read_b128 a[36:39], v42 offset:0
    buffer_load_dwordx4 v4, s[4:7], s32 offen offset:3072  lds
    s_waitcnt lgkmcnt(10)
    v_mfma_f32_32x32x16_bf16 v[64:79], a[8:11], a[0:3], v[64:79]
    ds_read_b64_tr_b16 a[44:45], v47 offset:24576
    ds_read_b64_tr_b16 a[46:47], v47 offset:25600
    v_mfma_f32_32x32x16_bf16 v[96:111], a[8:11], a[4:7], v[96:111]
    s_add_u32 m0, s31, 49152
    ds_read_b128 a[48:51], v39 offset:0
    ds_read_b64_tr_b16 a[56:57], v46 offset:28672
    buffer_load_dwordx4 v5, s[8:11], s33 offen  lds
    v_mfma_f32_32x32x16_bf16 v[80:95], a[12:15], a[0:3], v[80:95]
    ds_read_b64_tr_b16 a[58:59], v46 offset:29696
    ds_read_b128 a[52:55], v43 offset:0
    v_mfma_f32_32x32x16_bf16 v[112:127], a[12:15], a[4:7], v[112:127]
    ds_read_b64_tr_b16 a[60:61], v47 offset:28672
    ds_read_b64_tr_b16 a[62:63], v47 offset:29696
    buffer_load_dwordx4 v6, s[8:11], s33 offen offset:1024  lds
    s_waitcnt lgkmcnt(12)
    v_mfma_f32_32x32x16_bf16 v[64:79], a[24:27], a[16:19], v[64:79]
    v_mfma_f32_32x32x16_bf16 v[96:111], a[24:27], a[20:23], v[96:111]
    buffer_load_dwordx4 v7, s[8:11], s33 offen offset:2048  lds
    v_mfma_f32_32x32x16_bf16 v[80:95], a[28:31], a[16:19], v[80:95]
    v_mfma_f32_32x32x16_bf16 v[112:127], a[28:31], a[20:23], v[112:127]
    buffer_load_dwordx4 v8, s[8:11], s33 offen offset:3072  lds
    s_add_u32 s32, s32, 128
    s_and_b32 s32, s32, 0x7ff
    s_add_u32 s33, s33, 0x80000
    s_and_b32 s33, s33, 0x7fffff
    s_cmp_lg_u32 s29, 0
    s_waitcnt vmcnt(16) lgkmcnt(0)
    s_cbranch_scc1 L_qw3
    s_waitcnt vmcnt(8)
L_qw3:
    s_barrier
    v_mfma_f32_32x32x16_bf16 v[64:79], a[40:43], a[32:35], v[64:79]
    ds_read_b128 a[0:3], v9 offset:0
    ds_read_b64_tr_b16 a[8:9], v44 offset:16384
    v_mfma_f32_32x32x16_bf16 v[96:111], a[40:43], a[36:39], v[96:111]
    s_add_u32 m0, s31, 65536
    ds_read_b64_tr_b16 a[10:11], v44 offset:17408
    ds_read_b128 a[4:7], v32 offset:0
    buffer_load_dwordx4 v1, s[4:7], s32 offen  lds
    v_mfma_f32_32x32x16_bf16 v[80:95], a[44:47], a[32:35], v[80:95]
    ds_read_b64_tr_b16 a[12:13], v45 offset:16384
    ds_read_b64_tr_b16 a[14:15], v45 offset:17408
    v_mfma_f32_32x32x16_bf16 v[112:127], a[44:47], a[36:39], v[112:127]
    ds_read_b128 a[16:19], v10 offset:0
    ds_read_b64_tr_b16 a[24:25], v44 offset:20480
    buffer_load_dwordx4 v2, s[4:7], s32 offen offset:1024  lds
    v_mfma_f32_32x32x16_bf16 v[64:79], a[56:59], a[48:51], v[64:79]
    ds_read_b64_tr_b16 a[26:27], v44 offset:21504
    ds_read_b128 a[20:23], v33 offset:0
    v_mfma_f32_32x32x16_bf16 v[96:111], a[56:59], a[52:55], v[96:111]
    ds_read_b64_tr_b16 a[28:29], v45 offset:20480
    ds_read_b64_tr_b16 a[30:31], v45 offset:21504
    buffer_load_dwordx4 v3, s[4:7], s32 offen offset:2048  lds
    v_mfma_f32_32x32x16_bf16 v[80:95], a[60:63], a[48:51], v[80:95]
    ds_read_b128 a[32:35], v11 offset:0
    ds_read_b64_tr_b16 a[40:41], v44 offset:24576
    v_mfma_f32_32x32x16_bf16 v[112:127], a[60:63], a[52:55], v[112:127]
    ds_read_b64_tr_b16 a[42:43], v44 offset:25600
    ds_read_b128 a[36:39], v34 offset:0
    buffer_load_dwordx4 v4, s[4:7], s32 offen offset:3072  lds
    s_waitcnt lgkmcnt(10)
    v_mfma_f32_32x32x16_bf16 v[64:79], a[8:11], a[0:3], v[64:79]
    ds_read_b64_tr_b16 a[44:45], v45 offset:24576
    ds_read_b64_tr_b16 a[46:47], v45 offset:25600
    v_mfma_f32_32x32x16_bf16 v[96:111], a[8:11], a[4:7], v[96:111]
    s_add_u32 m0, s31, 81920
    ds_read_b128 a[48:51], v12 offset:0
    ds_read_b64_tr_b16 a[56:57], v44 offset:28672
    buffer_load_dwordx4 v5, s[8:11], s33 offen  lds
    v_mfma_f32_32x32x16_bf16 v[80:95], a[12:15], a[0:3], v[80:95]
    ds_read_b64_tr_b16 a[58:59], v44 offset:29696
    ds_read_b128 a[52:55], v35 offset:0
    v_mfma_f32_32x32x16_bf16 v[112:127], a[12:15], a[4:7], v[112:127]
    ds_read_b64_tr_b16 a[60:61], v45 offset:28672
    ds_read_b64_tr_b16 a[62:63], v45 offset:29696
    buffer_load_dwordx4 v6, s[8:11], s33 offen offset:1024  lds
    s_waitcnt lgkmcnt(12)
    v_mfma_f32_32x32x16_bf16 v[64:79], a[24:27], a[16:19], v[64:79]
    v_mfma_f32_32x32x16_bf16 v[96:111], a[24:27], a[20:23], v[96:111]
    buffer_load_dwordx4 v7, s[8:11], s33 offen offset:2048  lds
    v_mfma_f32_32x32x16_bf16 v[80:95], a[28:31], a[16:19], v[80:95]
    v_mfma_f32_32x32x16_bf16 v[112:127], a[28:31], a[20:23], v[112:127]
    buffer_load_dwordx4 v8, s[8:11], s33 offen offset:3072  lds
    s_add_u32 s32, s32, 128
    s_and_b32 s32, s32, 0x7ff
    s_add_u32 s33, s33, 0x80000
    s_and_b32 s33, s33, 0x7fffff
    s_waitcnt vmcnt(8) lgkmcnt(0)
    s_barrier
    s_mov_b32 s50, 0
    s_mov_b32 s51, 0
    v_mfma_f32_32x32x16_bf16 v[64:79], a[40:43], a[32:35], v[64:79]
    ds_read_b128 a[0:3], v9 offset:32768
    ds_read_b64_tr_b16 a[8:9], v44 offset:49152
    v_mfma_f32_32x32x16_bf16 v[96:111], a[40:43], a[36:39], v[96:111]
    ds_read_b64_tr_b16 a[10:11], v44 offset:50176
    ds_read_b128 a[4:7], v32 offset:32768
    s_lshl_b32 s47, s24, 13
    s_add_u32 s47, s47, 0
    s_add_u32 m0, s50, s47
    s_add_u32 s47, s47, s51
    buffer_load_dwordx4 v29, s[16:19], s47 offen nt lds
    v_mfma_f32_32x32x16_bf16 v[80:95], a[44:47], a[32:35], v[80:95]
    ds_read_b64_tr_b16 a[12:13], v45 offset:49152
    ds_read_b64_tr_b16 a[14:15], v45 offset:50176
    v_mfma_f32_32x32x16_bf16 v[112:127], a[44:47], a[36:39], v[112:127]
    ds_read_b128 a[16:19], v10 offset:32768
    ds_read_b64_tr_b16 a[24:25], v44 offset:53248
    buffer_load_dwordx4 v29, s[16:19], s47 offen offset:1024 nt lds
    v_mfma_f32_32x32x16_bf16 v[64:79], a[56:59], a[48:51], v[64:79]
    ds_read_b64_tr_b16 a[26:27], v44 offset:54272
    ds_read_b128 a[20:23], v33 offset:32768
    v_mfma_f32_32x32x16_bf16 v[96:111], a[56:59], a[52:55], v[96:111]
    ds_read_b64_tr_b16 a[28:29], v45 offset:53248
    ds_read_b64_tr_b16 a[30:31], v45 offset:54272
    buffer_load_dwordx4 v29, s[16:19], s47 offen offset:2048 nt lds
    v_mfma_f32_32x32x16_bf16 v[80:95], a[60:63], a[48:51], v[80:95]
    ds_read_b128 a[32:35], v11 offset:32768
    ds_read_b64_tr_b16 a[40:41], v44 offset:57344
    v_mfma_f32_32x32x16_bf16 v[112:127], a[60:63], a[52:55], v[112:127]
    ds_read_b64_tr_b16 a[42:43], v44 offset:58368
    ds_read_b128 a[36:39], v34 offset:32768
    buffer_load_dwordx4 v29, s[16:19], s47 offen offset:3072 nt lds
    s_waitcnt lgkmcnt(10)
    v_mfma_f32_32x32x16_bf16 v[64:79], a[8:11], a[0:3], v[64:79]
    ds_read_b64_tr_b16 a[44:45], v45 offset:57344
    ds_read_b64_tr_b16 a[46:47], v45 offset:58368
    v_mfma_f32_32x32x16_bf16 v[96:111], a[8:11], a[4:7], v[96:111]
    ds_read_b128 a[48:51], v12 offset:32768
    ds_read_b64_tr_b16 a[56:57], v44 offset:61440
    s_lshl_b32 s47, s24, 13
    s_add_u32 s47, s47, 4096
    s_add_u32 m0, s50, s47
    s_add_u32 s47, s47, s51
    buffer_load_dwordx4 v29, s[16:19], s47 offen nt lds
    v_mfma_f32_32x32x16_bf16 v[80:95], a[12:15], a[0:3], v[80:95]
    ds_read_b64_tr_b16 a[58:59], v44 offset:62464
    ds_read_b128 a[52:55], v35 offset:32768
    v_mfma_f32_32x32x16_bf16 v[112:127], a[12:15], a[4:7], v[112:127]
    ds_read_b64_tr_b16 a[60:61], v45 offset:61440
    ds_read_b64_tr_b16 a[62:63], v45 offset:62464
    buffer_load_dwordx4 v29, s[16:19], s47 offen offset:1024 nt lds
    s_waitcnt lgkmcnt(12)
    v_mfma_f32_32x32x16_bf16 v[64:79], a[24:27], a[16:19], v[64:79]
    v_mfma_f32_32x32x16_bf16 v[96:111], a[24:27], a[20:23], v[96:111]
    buffer_load_dwordx4 v29, s[16:19], s47 offen offset:2048 nt lds
    v_mfma_f32_32x32x16_bf16 v[80:95], a[28:31], a[16:19], v[80:95]
    v_mfma_f32_32x32x16_bf16 v[112:127], a[28:31], a[20:23], v[112:127]
    buffer_load_dwordx4 v29, s[16:19], s47 offen offset:3072 nt lds
    s_waitcnt vmcnt(8) lgkmcnt(0)
    s_barrier
    v_mfma_f32_32x32x16_bf16 v[64:79], a[40:43], a[32:35], v[64:79]
    ds_read_b128 a[0:3], v36 offset:0
    ds_read_b64_tr_b16 a[8:9], v46 offset:16384
    v_mfma_f32_32x32x16_bf16 v[96:111], a[40:43], a[36:39], v[96:111]
    ds_read_b64_tr_b16 a[10:11], v46 offset:17408
    ds_read_b128 a[4:7], v40 offset:0
    v_mfma_f32_32x32x16_bf16 v[80:95], a[44:47], a[32:35], v[80:95]
    ds_read_b64_tr_b16 a[12:13], v47 offset:16384
    ds_read_b64_tr_b16 a[14:15], v47 offset:17408
    v_mfma_f32_32x32x16_bf16 v[112:127], a[44:47], a[36:39], v[112:127]
    ds_read_b128 a[16:19], v37 offset:0
    ds_read_b64_tr_b16 a[24:25], v46 offset:20480
    v_mfma_f32_32x32x16_bf16 v[64:79], a[56:59], a[48:51], v[64:79]
    ds_read_b64_tr_b16 a[26:27], v46 offset:21504
    ds_read_b128 a[20:23], v41 offset:0
    v_mfma_f32_32x32x16_bf16 v[96:111], a[56:59], a[52:55], v[96:111]
    ds_read_b64_tr_b16 a[28:29], v47 offset:20480
    ds_read_b64_tr_b16 a[30:31], v47 offset:21504
    v_mfma_f32_32x32x16_bf16 v[80:95], a[60:63], a[48:51], v[80:95]
    ds_read_b128 a[32:35], v38 offset:0
    ds_read_b64_tr_b16 a[40:41], v46 offset:24576
    v_mfma_f32_32x32x16_bf16 v[112:127], a[60:63], a[52:55], v[112:127]
    ds_read_b64_tr_b16 a[42:43], v46 offset:25600
    ds_read_b128 a[36:39], v42 offset:0
    s_waitcnt lgkmcnt(10)
    v_mfma_f32_32x32x16_bf16 v[64:79], a[8:11], a[0:3], v[64:79]
    ds_read_b64_tr_b16 a[44:45], v47 offset:24576
    ds_read_b64_tr_b16 a[46:47], v47 offset:25600
    v_mfma_f32_32x32x16_bf16 v[96:111], a[8:11], a[4:7], v[96:111]
    ds_read_b128 a[48:51], v39 offset:0
    ds_read_b64_tr_b16 a[56:57], v46 offset:28672
    v_mfma_f32_32x32x16_bf16 v[80:95], a[12:15], a[0:3], v[80:95]
    ds_read_b64_tr_b16 a[58:59], v46 offset:29696
    ds_read_b128 a[52:55], v43 offset:0
    v_mfma_f32_32x32x16_bf16 v[112:127], a[12:15], a[4:7], v[112:127]
    ds_read_b64_tr_b16 a[60:61], v47 offset:28672
    ds_read_b64_tr_b16 a[62:63], v47 offset:29696
    s_waitcnt lgkmcnt(12)
    v_mfma_f32_32x32x16_bf16 v[64:79], a[24:27], a[16:19], v[64:79]
    v_mfma_f32_32x32x16_bf16 v[96:111], a[24:27], a[20:23], v[96:111]
    v_mfma_f32_32x32x16_bf16 v[80:95], a[28:31], a[16:19], v[80:95]
    v_mfma_f32_32x32x16_bf16 v[112:127], a[28:31], a[20:23], v[112:127]
    s_waitcnt lgkmcnt(0)
    s_mov_b32 s52, 1040356334
    s_xor_b32 s46, s24, 1
    s_lshl_b32 s46, s46, 13
    s_add_u32 s46, s46, 36864
    v_lshlrev_b32 v12, 4, v30
    v_add_u32 v12, s46, v12
    v_mfma_f32_32x32x16_bf16 v[96:111], a[40:43], a[36:39], v[96:111]
    v_mfma_f32_32x32x16_bf16 v[96:111], a[56:59], a[52:55], v[96:111]
    v_mfma_f32_32x32x16_bf16 v[112:127], a[44:47], a[36:39], v[112:127]
    v_mfma_f32_32x32x16_bf16 v[112:127], a[60:63], a[52:55], v[112:127]
    v_mfma_f32_32x32x16_bf16 v[64:79], a[40:43], a[32:35], v[64:79]
    s_nop 8
    v_mul_f32 v96, s52, v96
    v_mul_f32 v97, s52, v97
    v_mul_f32 v98, s52, v98
    v_mul_f32 v99, s52, v99
    v_mul_f32 v100, s52, v100
    v_mul_f32 v101, s52, v101
    v_mul_f32 v102, s52, v102
    v_mul_f32 v103, s52, v103
    v_cvt_pk_bf16_f32 v48, v96, v97
    v_cvt_pk_bf16_f32 v49, v98, v99
    v_cvt_pk_bf16_f32 v50, v100, v101
    v_cvt_pk_bf16_f32 v51, v102, v103
    v_mfma_f32_32x32x16_bf16 v[64:79], a[56:59], a[48:51], v[64:79]
    v_mul_f32 v104, s52, v104
    v_mul_f32 v105, s52, v105
    v_mul_f32 v106, s52, v106
    v_mul_f32 v107, s52, v107
    v_mul_f32 v108, s52, v108
    v_mul_f32 v109, s52, v109
    v_mul_f32 v110, s52, v110
    v_mul_f32 v111, s52, v111
    v_cvt_pk_bf16_f32 v52, v104, v105
    v_cvt_pk_bf16_f32 v53, v106, v107
    v_cvt_pk_bf16_f32 v54, v108, v109
    v_cvt_pk_bf16_f32 v55, v110, v111
    v_mfma_f32_32x32x16_bf16 v[80:95], a[44:47], a[32:35], v[80:95]
    v_mul_f32 v112, s52, v112
    v_mul_f32 v113, s52, v113
    v_mul_f32 v114, s52, v114
    v_mul_f32 v115, s52, v115
    v_mul_f32 v116, s52, v116
    v_mul_f32 v117, s52, v117
    v_mul_f32 v118, s52, v118
    v_mul_f32 v119, s52, v119
    v_cvt_pk_bf16_f32 v56, v112, v113
    v_cvt_pk_bf16_f32 v57, v114, v115
    v_cvt_pk_bf16_f32 v58, v116, v117
    v_cvt_pk_bf16_f32 v59, v118, v119
    v_mfma_f32_32x32x16_bf16 v[80:95], a[60:63], a[48:51], v[80:95]
    v_mul_f32 v120, s52, v120
    v_mul_f32 v121, s52, v121
    v_mul_f32 v122, s52, v122
    v_mul_f32 v123, s52, v123
    v_mul_f32 v124, s52, v124
    v_mul_f32 v125, s52, v125
    v_mul_f32 v126, s52, v126
    v_mul_f32 v127, s52, v127
    v_cvt_pk_bf16_f32 v60, v120, v121
    v_cvt_pk_bf16_f32 v61, v122, v123
    v_cvt_pk_bf16_f32 v62, v124, v125
    v_cvt_pk_bf16_f32 v63, v126, v127
    ds_write_b128 v12, v[48:51] offset:0
    ds_write_b128 v12, v[52:55] offset:1024
    ds_write_b128 v12, v[56:59] offset:2048
    ds_write_b128 v12, v[60:63] offset:3072
    v_mul_f32 v64, s52, v64
    v_mul_f32 v65, s52, v65
    v_mul_f32 v66, s52, v66
    v_mul_f32 v67, s52, v67
    v_mul_f32 v68, s52, v68
    v_mul_f32 v69, s52, v69
    v_mul_f32 v70, s52, v70
    v_mul_f32 v71, s52, v71
    v_cvt_pk_bf16_f32 v32, v64, v65
    v_cvt_pk_bf16_f32 v33, v66, v67
    v_cvt_pk_bf16_f32 v34, v68, v69
    v_cvt_pk_bf16_f32 v35, v70, v71
    v_mul_f32 v72, s52, v72
    v_mul_f32 v73, s52, v73
    v_mul_f32 v74, s52, v74
    v_mul_f32 v75, s52, v75
    v_mul_f32 v76, s52, v76
    v_mul_f32 v77, s52, v77
    v_mul_f32 v78, s52, v78
    v_mul_f32 v79, s52, v79
    v_cvt_pk_bf16_f32 v36, v72, v73
    v_cvt_pk_bf16_f32 v37, v74, v75
    v_cvt_pk_bf16_f32 v38, v76, v77
    v_cvt_pk_bf16_f32 v39, v78, v79
    v_mul_f32 v80, s52, v80
    v_mul_f32 v81, s52, v81
    v_mul_f32 v82, s52, v82
    v_mul_f32 v83, s52, v83
    v_mul_f32 v84, s52, v84
    v_mul_f32 v85, s52, v85
    v_mul_f32 v86, s52, v86
    v_mul_f32 v87, s52, v87
    v_cvt_pk_bf16_f32 v40, v80, v81
    v_cvt_pk_bf16_f32 v41, v82, v83
    v_cvt_pk_bf16_f32 v42, v84, v85
    v_cvt_pk_bf16_f32 v43, v86, v87
    v_mul_f32 v88, s52, v88
    v_mul_f32 v89, s52, v89
    v_mul_f32 v90, s52, v90
    v_mul_f32 v91, s52, v91
    v_mul_f32 v92, s52, v92
    v_mul_f32 v93, s52, v93
    v_mul_f32 v94, s52, v94
    v_mul_f32 v95, s52, v95
    v_cvt_pk_bf16_f32 v44, v88, v89
    v_cvt_pk_bf16_f32 v45, v90, v91
    v_cvt_pk_bf16_f32 v46, v92, v93
    v_cvt_pk_bf16_f32 v47, v94, v95
    s_lshl_b32 s46, s24, 13
    s_add_u32 s46, s46, 36864
    v_lshlrev_b32 v12, 4, v30
    v_add_u32 v12, s46, v12
    s_waitcnt lgkmcnt(0)
    s_or_b32 s46, s2, s24
    s_cmp_lg_u32 s46, 0
    s_cbranch_scc1 L_nopub
    v_add_co_u32 v134, vcc, 1, v134
    s_nop 1
    v_addc_co_u32 v135, vcc, 0, v135, vcc
    v_cmp_eq_u32 vcc, 0, v134
    s_nop 1
    v_cndmask_b32 v134, v134, 1.0, vcc
    v_cmp_eq_u32 vcc, 0, v30
    s_nop 3
    s_and_saveexec_b64 s[46:47], vcc
    global_store_dwordx2 v132, v[134:135], s[94:95] sc1
    v_mov_b32 v133, 0
    global_store_dwordx2 v133, v[134:135], s[92:93] sc1
    s_mov_b64 exec, s[46:47]
L_nopub:
L_att0:
    v_mov_b32 v2, 0
    v_mov_b32 v9, 0
    v_mov_b32 v10, 0
    v_mov_b32 v11, 0
    s_mov_b32 s52, 1090519040
    s_mov_b32 s98, 0
    s_mov_b32 s53, 98304
    v_add_u32 v17, s53, v17
    v_add_u32 v18, s53, v18
    v_add_u32 v19, s53, v19
    v_add_u32 v20, s53, v20
    v_add_u32 v21, s53, v21
    v_add_u32 v22, s53, v22
    v_add_u32 v23, s53, v23
    v_add_u32 v24, s53, v24
    s_mov_b32 s55, 0
    s_mov_b32 s62, 0x314
    s_mov_b32 s63, 0x042
    s_mov_b32 s54, 32768
    s_mov_b32 s50, 65536
    s_mov_b32 s51, 32768
    s_mov_b32 s30, 0
    s_waitcnt vmcnt(8)
    s_barrier
    s_cmp_lg_u32 s24, 1
    s_cbranch_scc1 L_nopfc2
    s_getpc_b64 s[46:47]
L_pc2:
    s_add_u32 s46, s46, L_p2-L_pc2
    s_addc_u32 s47, s47, 0
    s_lshr_b32 s34, s2, 3
    s_lshl_b32 s34, s34, 10
    v_lshlrev_b32 v162, 4, v30
    v_add_u32 v162, s34, v162
    s_mov_b32 s35, L_end-L_p2-16
    v_cmp_gt_u32 vcc, s35, v162
    s_nop 3
    s_and_saveexec_b64 s[34:35], vcc
    s_cbranch_execz L_pfc2_done
    global_load_dwordx4 v[164:167], v162, s[46:47]
L_pfc2_done:
    s_mov_b64 exec, s[34:35]
L_nopfc2:
    ds_read_b128 v[48:51], v12 offset:0
    ds_read_b128 v[52:55], v12 offset:1024
    ds_read_b128 v[56:59], v12 offset:2048
    ds_read_b128 v[60:63], v12 offset:3072
    ds_read_b128 a[0:3], v17 offset:0
    ds_read_b128 a[4:7], v18 offset:0
    ds_read_b128 a[8:11], v19 offset:0
    ds_read_b128 a[12:15], v20 offset:0
    ds_read_b128 a[16:19], v21 offset:0
    ds_read_b128 a[20:23], v22 offset:0
    s_lshl_b32 s47, s24, 13
    s_add_u32 s47, s47, 0
    s_add_u32 m0, s54, s47
    s_add_u32 s47, s47, s50
    buffer_load_dwordx4 v25, s[12:15], s47 offen nt lds
    buffer_load_dwordx4 v26, s[12:15], s47 offen offset:1024 nt lds
    buffer_load_dwordx4 v27, s[12:15], s47 offen offset:2048 nt lds
    buffer_load_dwordx4 v28, s[12:15], s47 offen offset:3072 nt lds
    s_waitcnt lgkmcnt(4)
    v_mfma_f32_32x32x16_bf16 v[64:79], a[0:3], v[32:35], 0
    ds_read_b128 a[24:27], v23 offset:0
    ds_read_b128 a[28:31], v24 offset:0
    v_mov_b32 v192, 0
    v_mov_b32 v193, 0
    v_mov_b32 v194, 0
    v_mov_b32 v195, 0
    v_mfma_f32_32x32x16_bf16 v[64:79], a[4:7], v[36:39], v[64:79]
    v_mov_b32 v196, 0
    v_mov_b32 v197, 0
    v_mov_b32 v198, 0
    s_waitcnt lgkmcnt(4)
    v_mfma_f32_32x32x16_bf16 v[64:79], a[8:11], v[40:43], v[64:79]
    ds_read_b128 a[0:3], v17 offset:8192
    ds_read_b128 a[4:7], v18 offset:8192
    v_mov_b32 v199, 0
    v_mov_b32 v200, 0
    v_mov_b32 v201, 0
    v_mov_b32 v202, 0
    v_mfma_f32_32x32x16_bf16 v[64:79], a[12:15], v[44:47], v[64:79]
    v_mov_b32 v203, 0
    v_mov_b32 v204, 0
    v_mov_b32 v205, 0
    s_waitcnt lgkmcnt(4)
    v_mfma_f32_32x32x16_bf16 v[64:79], a[16:19], v[48:51], v[64:79]
    ds_read_b128 a[8:11], v19 offset:8192
    ds_read_b128 a[12:15], v20 offset:8192
    v_mov_b32 v206, 0
    v_mov_b32 v207, 0
    v_mov_b32 v208, 0
    v_mov_b32 v209, 0
    v_mfma_f32_32x32x16_bf16 v[64:79], a[20:23], v[52:55], v[64:79]
    v_mov_b32 v210, 0
    v_mov_b32 v211, 0
    v_mov_b32 v212, 0
    s_waitcnt lgkmcnt(4)
    v_mfma_f32_32x32x16_bf16 v[64:79], a[24:27], v[56:59], v[64:79]
    ds_read_b128 a[16:19], v21 offset:8192
    ds_read_b128 a[20:23], v22 offset:8192
    v_mov_b32 v213, 0
    v_mov_b32 v214, 0
    v_mov_b32 v215, 0
    v_mov_b32 v216, 0
    v_mfma_f32_32x32x16_bf16 v[64:79], a[28:31], v[60:63], v[64:79]
    v_mov_b32 v217, 0
    v_mov_b32 v218, 0
    v_mov_b32 v219, 0
    s_waitcnt lgkmcnt(4)
    v_mfma_f32_32x32x16_bf16 v[80:95], a[0:3], v[32:35], 0
    ds_read_b128 a[24:27], v23 offset:8192
    ds_read_b128 a[28:31], v24 offset:8192
    v_mov_b32 v220, 0
    v_mov_b32 v221, 0
    v_mov_b32 v222, 0
    v_mov_b32 v223, 0
    v_mfma_f32_32x32x16_bf16 v[80:95], a[4:7], v[36:39], v[80:95]
    v_mov_b32 v176, 0
    v_mov_b32 v177, 0
    v_mov_b32 v178, 0
    s_waitcnt lgkmcnt(4)
    v_mfma_f32_32x32x16_bf16 v[80:95], a[8:11], v[40:43], v[80:95]
    ds_read_b128 a[0:3], v17 offset:16384
    ds_read_b128 a[4:7], v18 offset:16384
    v_mov_b32 v179, 0
    v_mov_b32 v180, 0
    v_mov_b32 v181, 0
    v_mov_b32 v182, 0
    v_mfma_f32_32x32x16_bf16 v[80:95], a[12:15], v[44:47], v[80:95]
    v_mov_b32 v183, 0
    v_mov_b32 v184, 0
    v_mov_b32 v185, 0
    s_waitcnt lgkmcnt(4)
    v_mfma_f32_32x32x16_bf16 v[80:95], a[16:19], v[48:51], v[80:95]
    ds_read_b128 a[8:11], v19 offset:16384
    ds_read_b128 a[12:15], v20 offset:16384
    v_mov_b32 v186, 0
    v_mov_b32 v187, 0
    v_mov_b32 v188, 0
    v_mov_b32 v189, 0
    v_mfma_f32_32x32x16_bf16 v[80:95], a[20:23], v[52:55], v[80:95]
    v_mov_b32 v190, 0
    v_mov_b32 v191, 0
    v_max3_f32 v5, v64, v65, v66
    s_waitcnt lgkmcnt(4)
    v_mfma_f32_32x32x16_bf16 v[80:95], a[24:27], v[56:59], v[80:95]
    ds_read_b128 a[16:19], v21 offset:16384
    ds_read_b128 a[20:23], v22 offset:16384
    v_max3_f32 v5, v5, v67, v68
    v_max3_f32 v5, v5, v69, v70
    v_max3_f32 v5, v5, v71, v72
    v_max3_f32 v5, v5, v73, v74
    v_mfma_f32_32x32x16_bf16 v[80:95], a[28:31], v[60:63], v[80:95]
    v_max3_f32 v5, v5, v75, v76
    v_max3_f32 v5, v5, v77, v78
    v_max_f32 v5, v5, v79
    s_lshl_b32 s47, s24, 13
    s_add_u32 s47, s47, 4096
    s_add_u32 m0, s54, s47
    s_add_u32 s47, s47, s50
    buffer_load_dwordx4 v25, s[12:15], s47 offen nt lds
    buffer_load_dwordx4 v26, s[12:15], s47 offen offset:1024 nt lds
    buffer_load_dwordx4 v27, s[12:15], s47 offen offset:2048 nt lds
    buffer_load_dwordx4 v28, s[12:15], s47 offen offset:3072 nt lds
    s_add_u32 s54, s54, 32768
    s_cmp_eq_u32 s54, 163840
    s_cselect_b32 s54, 0, s54
    s_add_u32 s50, s50, 32768
    s_waitcnt lgkmcnt(4)
    v_mfma_f32_32x32x16_bf16 v[96:111], a[0:3], v[32:35], 0
    ds_read_b128 a[24:27], v23 offset:16384
    ds_read_b128 a[28:31], v24 offset:16384
    v_mov_b32 v224, 0
    v_mov_b32 v225, 0
    v_mov_b32 v226, 0
    v_mfma_f32_32x32x16_bf16 v[96:111], a[4:7], v[36:39], v[96:111]
    v_mov_b32 v227, 0
    v_mov_b32 v228, 0
    v_mov_b32 v229, 0
    s_waitcnt lgkmcnt(4)
    v_mfma_f32_32x32x16_bf16 v[96:111], a[8:11], v[40:43], v[96:111]
    ds_read_b128 a[0:3], v17 offset:24576
    ds_read_b128 a[4:7], v18 offset:24576
    v_mov_b32 v230, 0
    v_mov_b32 v231, 0
    v_mov_b32 v232, 0
    v_mfma_f32_32x32x16_bf16 v[96:111], a[12:15], v[44:47], v[96:111]
    v_mov_b32 v233, 0
    v_mov_b32 v234, 0
    v_mov_b32 v235, 0
    s_waitcnt lgkmcnt(4)
    v_mfma_f32_32x32x16_bf16 v[96:111], a[16:19], v[48:51], v[96:111]
    ds_read_b128 a[8:11], v19 offset:24576
    ds_read_b128 a[12:15], v20 offset:24576
    v_mov_b32 v236, 0
    v_mov_b32 v237, 0
    v_mov_b32 v238, 0
    v_mfma_f32_32x32x16_bf16 v[96:111], a[20:23], v[52:55], v[96:111]
    v_mov_b32 v239, 0
    v_mov_b32 v240, 0
    v_mov_b32 v241, 0
    s_waitcnt lgkmcnt(4)
    v_mfma_f32_32x32x16_bf16 v[96:111], a[24:27], v[56:59], v[96:111]
    ds_read_b128 a[16:19], v21 offset:24576
    ds_read_b128 a[20:23], v22 offset:24576
    v_mov_b32 v242, 0
    v_mov_b32 v243, 0
    v_mov_b32 v244, 0
    v_mfma_f32_32x32x16_bf16 v[96:111], a[28:31], v[60:63], v[96:111]
    v_mov_b32 v245, 0
    v_mov_b32 v246, 0
    v_mov_b32 v247, 0
    s_waitcnt lgkmcnt(4)
    v_mfma_f32_32x32x16_bf16 v[112:127], a[0:3], v[32:35], 0
    ds_read_b128 a[24:27], v23 offset:24576
    ds_read_b128 a[28:31], v24 offset:24576
    v_mov_b32 v248, 0
    v_mov_b32 v249, 0
    v_mov_b32 v250, 0
    v_mfma_f32_32x32x16_bf16 v[112:127], a[4:7], v[36:39], v[112:127]
    v_mov_b32 v251, 0
    v_mov_b32 v252, 0
    v_mov_b32 v253, 0
    s_waitcnt lgkmcnt(4)
    v_mfma_f32_32x32x16_bf16 v[112:127], a[8:11], v[40:43], v[112:127]
    v_mov_b32 v254, 0
    v_mov_b32 v255, 0
    v_max3_f32 v6, v80, v81, v82
    v_mfma_f32_32x32x16_bf16 v[112:127], a[12:15], v[44:47], v[112:127]
    v_max3_f32 v6, v6, v83, v84
    v_max3_f32 v6, v6, v85, v86
    v_max3_f32 v6, v6, v87, v88
    s_waitcnt lgkmcnt(2)
    v_mfma_f32_32x32x16_bf16 v[112:127], a[16:19], v[48:51], v[112:127]
    v_max3_f32 v6, v6, v89, v90
    v_max3_f32 v6, v6, v91, v92
    v_max3_f32 v6, v6, v93, v94
    v_mfma_f32_32x32x16_bf16 v[112:127], a[20:23], v[52:55], v[112:127]
    v_max_f32 v6, v6, v95
    v_max3_f32 v7, v96, v97, v98
    v_max3_f32 v7, v7, v99, v100
    s_waitcnt lgkmcnt(0)
    v_mfma_f32_32x32x16_bf16 v[112:127], a[24:27], v[56:59], v[112:127]
    v_max3_f32 v7, v7, v101, v102
    v_max3_f32 v7, v7, v103, v104
    v_max3_f32 v7, v7, v105, v106
    v_mfma_f32_32x32x16_bf16 v[112:127], a[28:31], v[60:63], v[112:127]
    v_max3_f32 v7, v7, v107, v108
    v_max3_f32 v7, v7, v109, v110
    v_max_f32 v7, v7, v111
    v_add_u32 v17, 32768, v17
    v_add_u32 v18, 32768, v18
    v_add_u32 v19, 32768, v19
    v_add_u32 v20, 32768, v20
    v_add_u32 v21, 32768, v21
    v_add_u32 v22, 32768, v22
    v_add_u32 v23, 32768, v23
    v_add_u32 v24, 32768, v24
    s_waitcnt vmcnt(16)
    s_barrier
    v_max3_f32 v8, v112, v113, v114
    v_max3_f32 v8, v8, v115, v116
    v_max3_f32 v8, v8, v117, v118
    v_max3_f32 v8, v8, v119, v120
    v_max3_f32 v8, v8, v121, v122
    v_max3_f32 v8, v8, v123, v124
    v_max3_f32 v8, v8, v125, v126
    v_max_f32 v8, v8, v127
    v_max3_f32 v5, v5, v6, v7
    v_max_f32 v5, v5, v8
    v_cmp_lt_f32 vcc, s52, |v5|
    ds_read_b128 a[0:3], v17 offset:0
    ds_read_b128 a[4:7], v18 offset:0
    ds_read_b128 a[8:11], v19 offset:0
    ds_read_b128 a[12:15], v20 offset:0
    ds_read_b128 a[16:19], v21 offset:0
    ds_read_b128 a[20:23], v22 offset:0
    s_cbranch_vccnz L_raise0
L_raise0_back:
    s_lshl_b32 s47, s24, 13
    s_add_u32 s47, s47, 0
    s_add_u32 m0, s54, s47
    s_add_u32 s47, s47, s51
    buffer_load_dwordx4 v29, s[16:19], s47 offen nt lds
    buffer_load_dwordx4 v29, s[16:19], s47 offen offset:1024 nt lds
    buffer_load_dwordx4 v29, s[16:19], s47 offen offset:2048 nt lds
    buffer_load_dwordx4 v29, s[16:19], s47 offen offset:3072 nt lds
    v_exp_f32 v64, v64
    v_exp_f32 v65, v65
    v_exp_f32 v66, v66
    v_exp_f32 v67, v67
    v_exp_f32 v68, v68
    v_exp_f32 v69, v69
    v_exp_f32 v70, v70
    v_exp_f32 v71, v71
    v_add_f32 v2, v2, v64
    v_add_f32 v9, v9, v65
    v_add_f32 v10, v10, v66
    v_add_f32 v11, v11, v67
    v_exp_f32 v72, v72
    v_exp_f32 v73, v73
    v_exp_f32 v74, v74
    v_exp_f32 v75, v75
    v_add_f32 v2, v2, v68
    v_add_f32 v9, v9, v69
    v_add_f32 v10, v10, v70
    v_add_f32 v11, v11, v71
    v_cvt_pk_bf16_f32 v128, v64, v65
    v_cvt_pk_bf16_f32 v129, v66, v67
    v_cvt_pk_bf16_f32 v130, v68, v69
    v_cvt_pk_bf16_f32 v131, v70, v71
    v_exp_f32 v76, v76
    v_exp_f32 v77, v77
    v_exp_f32 v78, v78
    v_exp_f32 v79, v79
    v_add_f32 v2, v2, v72
    v_add_f32 v9, v9, v73
    v_add_f32 v10, v10, v74
    v_add_f32 v11, v11, v75
    v_cvt_pk_bf16_f32 v132, v72, v73
    v_cvt_pk_bf16_f32 v133, v74, v75
    v_add_f32 v2, v2, v76
    v_add_f32 v9, v9, v77
    v_add_f32 v10, v10, v78
    v_add_f32 v11, v11, v79
    v_cvt_pk_bf16_f32 v134, v76, v77
    v_cvt_pk_bf16_f32 v135, v78, v79
    s_cmp_lg_u32 s98, 0
    s_cbranch_scc1 L_rs_a0
L_rs_a0_back:
    s_waitcnt lgkmcnt(4)
    v_mfma_f32_32x32x16_bf16 v[64:79], a[0:3], v[32:35], v[176:191]
    ds_read_b128 a[24:27], v23 offset:0
    ds_read_b128 a[28:31], v24 offset:0
    v_exp_f32 v80, v80
    v_exp_f32 v81, v81
    v_exp_f32 v82, v82
    v_exp_f32 v83, v83
    v_mfma_f32_32x32x16_bf16 v[64:79], a[4:7], v[36:39], v[64:79]
    v_exp_f32 v84, v84
    v_exp_f32 v85, v85
    v_exp_f32 v86, v86
    s_waitcnt lgkmcnt(4)
    v_mfma_f32_32x32x16_bf16 v[64:79], a[8:11], v[40:43], v[64:79]
    ds_read_b128 a[0:3], v17 offset:8192
    ds_read_b128 a[4:7], v18 offset:8192
    v_exp_f32 v87, v87
    v_add_f32 v2, v2, v80
    v_add_f32 v9, v9, v81
    v_add_f32 v10, v10, v82
    v_add_f32 v11, v11, v83
    v_exp_f32 v88, v88
    v_mfma_f32_32x32x16_bf16 v[64:79], a[12:15], v[44:47], v[64:79]
    v_exp_f32 v89, v89
    v_exp_f32 v90, v90
    v_exp_f32 v91, v91
    s_waitcnt lgkmcnt(4)
    v_mfma_f32_32x32x16_bf16 v[64:79], a[16:19], v[48:51], v[64:79]
    ds_read_b128 a[8:11], v19 offset:8192
    ds_read_b128 a[12:15], v20 offset:8192
    v_add_f32 v2, v2, v84
    v_add_f32 v9, v9, v85
    v_add_f32 v10, v10, v86
    v_add_f32 v11, v11, v87
    v_cvt_pk_bf16_f32 v136, v80, v81
    v_cvt_pk_bf16_f32 v137, v82, v83
    v_cvt_pk_bf16_f32 v138, v84, v85
    v_mfma_f32_32x32x16_bf16 v[64:79], a[20:23], v[52:55], v[64:79]
    v_cvt_pk_bf16_f32 v139, v86, v87
    v_exp_f32 v92, v92
    v_exp_f32 v93, v93
    v_exp_f32 v94, v94
    s_waitcnt lgkmcnt(4)
    v_mfma_f32_32x32x16_bf16 v[64:79], a[24:27], v[56:59], v[64:79]
    ds_read_b128 a[16:19], v21 offset:8192
    ds_read_b128 a[20:23], v22 offset:8192
    v_exp_f32 v95, v95
    v_add_f32 v2, v2, v88
    v_add_f32 v9, v9, v89
    v_add_f32 v10, v10, v90
    v_add_f32 v11, v11, v91
    v_cvt_pk_bf16_f32 v140, v88, v89
    v_mfma_f32_32x32x16_bf16 v[64:79], a[28:31], v[60:63], v[64:79]
    v_cvt_pk_bf16_f32 v141, v90, v91
    v_add_f32 v2, v2, v92
    v_add_f32 v9, v9, v93
    v_add_f32 v10, v10, v94
    v_add_f32 v11, v11, v95
    v_cvt_pk_bf16_f32 v142, v92, v93
    v_cvt_pk_bf16_f32 v143, v94, v95
    s_waitcnt lgkmcnt(4)
    v_mfma_f32_32x32x16_bf16 v[80:95], a[0:3], v[32:35], v[176:191]
    ds_read_b128 a[24:27], v23 offset:8192
    ds_read_b128 a[28:31], v24 offset:8192
    v_exp_f32 v96, v96
    v_exp_f32 v97, v97
    v_exp_f32 v98, v98
    v_exp_f32 v99, v99
    v_mfma_f32_32x32x16_bf16 v[80:95], a[4:7], v[36:39], v[80:95]
    v_exp_f32 v100, v100
    v_exp_f32 v101, v101
    v_exp_f32 v102, v102
    s_waitcnt lgkmcnt(4)
    v_mfma_f32_32x32x16_bf16 v[80:95], a[8:11], v[40:43], v[80:95]
    ds_read_b128 a[0:3], v17 offset:16384
    ds_read_b128 a[4:7], v18 offset:16384
    v_exp_f32 v103, v103
    v_add_f32 v2, v2, v96
    v_add_f32 v9, v9, v97
    v_add_f32 v10, v10, v98
    v_add_f32 v11, v11, v99
    v_exp_f32 v104, v104
    v_mfma_f32_32x32x16_bf16 v[80:95], a[12:15], v[44:47], v[80:95]
    v_exp_f32 v105, v105
    v_exp_f32 v106, v106
    v_exp_f32 v107, v107
    s_waitcnt lgkmcnt(4)
    v_mfma_f32_32x32x16_bf16 v[80:95], a[16:19], v[48:51], v[80:95]
    ds_read_b128 a[8:11], v19 offset:16384
    ds_read_b128 a[12:15], v20 offset:16384
    v_add_f32 v2, v2, v100
    v_add_f32 v9, v9, v101
    v_add_f32 v10, v10, v102
    v_add_f32 v11, v11, v103
    v_cvt_pk_bf16_f32 v144, v96, v97
    v_cvt_pk_bf16_f32 v145, v98, v99
    v_cvt_pk_bf16_f32 v146, v100, v101
    v_mfma_f32_32x32x16_bf16 v[80:95], a[20:23], v[52:55], v[80:95]
    v_cvt_pk_bf16_f32 v147, v102, v103
    v_exp_f32 v108, v108
    v_exp_f32 v109, v109
    v_exp_f32 v110, v110
    s_waitcnt lgkmcnt(4)
    v_mfma_f32_32x32x16_bf16 v[80:95], a[24:27], v[56:59], v[80:95]
    ds_read_b128 a[16:19], v21 offset:16384
    ds_read_b128 a[20:23], v22 offset:16384
    v_exp_f32 v111, v111
    v_add_f32 v2, v2, v104
    v_add_f32 v9, v9, v105
    v_add_f32 v10, v10, v106
    v_add_f32 v11, v11, v107
    v_cvt_pk_bf16_f32 v148, v104, v105
    v_mfma_f32_32x32x16_bf16 v[80:95], a[28:31], v[60:63], v[80:95]
    v_cvt_pk_bf16_f32 v149, v106, v107
    v_add_f32 v2, v2, v108
    v_add_f32 v9, v9, v109
    v_add_f32 v10, v10, v110
    v_add_f32 v11, v11, v111
    v_cvt_pk_bf16_f32 v150, v108, v109
    v_cvt_pk_bf16_f32 v151, v110, v111
    s_waitcnt vmcnt(12)
    s_barrier
    s_waitcnt lgkmcnt(4)
    v_mfma_f32_32x32x16_bf16 v[96:111], a[0:3], v[32:35], v[176:191]
    ds_read_b128 a[24:27], v23 offset:16384
    ds_read_b128 a[28:31], v24 offset:16384
    v_exp_f32 v112, v112
    v_exp_f32 v113, v113
    v_exp_f32 v114, v114
    v_exp_f32 v115, v115
    v_mfma_f32_32x32x16_bf16 v[96:111], a[4:7], v[36:39], v[96:111]
    s_lshl_b32 s47, s24, 13
    s_add_u32 s47, s47, 4096
    s_add_u32 m0, s54, s47
    s_add_u32 s47, s47, s51
    buffer_load_dwordx4 v29, s[16:19], s47 offen nt lds
    v_exp_f32 v116, v116
    v_exp_f32 v117, v117
    v_exp_f32 v118, v118
    s_waitcnt lgkmcnt(4)
    v_mfma_f32_32x32x16_bf16 v[96:111], a[8:11], v[40:43], v[96:111]
    ds_read_b128 a[0:3], v17 offset:24576
    ds_read_b128 a[4:7], v18 offset:24576
    buffer_load_dwordx4 v29, s[16:19], s47 offen offset:1024 nt lds
    v_exp_f32 v119, v119
    v_add_f32 v2, v2, v112
    v_add_f32 v9, v9, v113
    v_add_f32 v10, v10, v114
    v_add_f32 v11, v11, v115
    v_exp_f32 v120, v120
    v_mfma_f32_32x32x16_bf16 v[96:111], a[12:15], v[44:47], v[96:111]
    buffer_load_dwordx4 v29, s[16:19], s47 offen offset:2048 nt lds
    v_exp_f32 v121, v121
    v_exp_f32 v122, v122
    v_exp_f32 v123, v123
    s_waitcnt lgkmcnt(4)
    v_mfma_f32_32x32x16_bf16 v[96:111], a[16:19], v[48:51], v[96:111]
    ds_read_b128 a[8:11], v19 offset:24576
    ds_read_b128 a[12:15], v20 offset:24576
    v_add_f32 v2, v2, v116
    v_add_f32 v9, v9, v117
    v_add_f32 v10, v10, v118
    v_add_f32 v11, v11, v119
    v_cvt_pk_bf16_f32 v152, v112, v113
    v_cvt_pk_bf16_f32 v153, v114, v115
    v_cvt_pk_bf16_f32 v154, v116, v117
    v_mfma_f32_32x32x16_bf16 v[96:111], a[20:23], v[52:55], v[96:111]
    buffer_load_dwordx4 v29, s[16:19], s47 offen offset:3072 nt lds
    v_cvt_pk_bf16_f32 v155, v118, v119
    v_exp_f32 v124, v124
    v_exp_f32 v125, v125
    v_exp_f32 v126, v126
    s_waitcnt lgkmcnt(4)
    v_mfma_f32_32x32x16_bf16 v[96:111], a[24:27], v[56:59], v[96:111]
    ds_read_b128 a[16:19], v21 offset:24576
    ds_read_b128 a[20:23], v22 offset:24576
    s_add_u32 s54, s54, 32768
    s_cmp_eq_u32 s54, 163840
    s_cselect_b32 s54, 0, s54
    s_add_u32 s51, s51, 32768
    v_exp_f32 v127, v127
    v_add_f32 v2, v2, v120
    v_add_f32 v9, v9, v121
    v_add_f32 v10, v10, v122
    v_add_f32 v11, v11, v123
    v_cvt_pk_bf16_f32 v156, v120, v121
    v_mfma_f32_32x32x16_bf16 v[96:111], a[28:31], v[60:63], v[96:111]
    v_cvt_pk_bf16_f32 v157, v122, v123
    v_add_f32 v2, v2, v124
    v_add_f32 v9, v9, v125
    v_add_f32 v10, v10, v126
    v_add_f32 v11, v11, v127
    v_cvt_pk_bf16_f32 v158, v124, v125
    v_cvt_pk_bf16_f32 v159, v126, v127
    s_waitcnt lgkmcnt(4)
    v_mfma_f32_32x32x16_bf16 v[112:127], a[0:3], v[32:35], v[176:191]
    ds_read_b128 a[24:27], v23 offset:24576
    ds_read_b128 a[28:31], v24 offset:24576
    v_mfma_f32_32x32x16_bf16 v[112:127], a[4:7], v[36:39], v[112:127]
    s_waitcnt lgkmcnt(4)
    v_mfma_f32_32x32x16_bf16 v[112:127], a[8:11], v[40:43], v[112:127]
    ds_read_b64_tr_b16 a[32:33], v13 offset:0
    ds_read_b64_tr_b16 a[34:35], v13 offset:1024
    v_mfma_f32_32x32x16_bf16 v[112:127], a[12:15], v[44:47], v[112:127]
    ds_read_b64_tr_b16 a[36:37], v14 offset:0
    ds_read_b64_tr_b16 a[38:39], v14 offset:1024
    s_waitcnt lgkmcnt(6)
    v_mfma_f32_32x32x16_bf16 v[112:127], a[16:19], v[48:51], v[112:127]
    ds_read_b64_tr_b16 a[40:41], v15 offset:0
    ds_read_b64_tr_b16 a[42:43], v15 offset:1024
    v_mfma_f32_32x32x16_bf16 v[112:127], a[20:23], v[52:55], v[112:127]
    ds_read_b64_tr_b16 a[44:45], v16 offset:0
    ds_read_b64_tr_b16 a[46:47], v16 offset:1024
    s_waitcnt lgkmcnt(8)
    v_mfma_f32_32x32x16_bf16 v[112:127], a[24:27], v[56:59], v[112:127]
    v_mfma_f32_32x32x16_bf16 v[112:127], a[28:31], v[60:63], v[112:127]
    v_add_u32 v17, 4294868992, v17
    v_add_u32 v18, 4294868992, v18
    v_add_u32 v19, 4294868992, v19
    v_add_u32 v20, 4294868992, v20
    v_add_u32 v21, 4294868992, v21
    v_add_u32 v22, 4294868992, v22
    v_add_u32 v23, 4294868992, v23
    v_add_u32 v24, 4294868992, v24
    s_waitcnt lgkmcnt(4)
    v_mfma_f32_32x32x16_bf16 v[192:207], a[32:35], v[128:131], v[192:207]
    ds_read_b64_tr_b16 a[48:49], v13 offset:4096
    ds_read_b64_tr_b16 a[50:51], v13 offset:5120
    v_max3_f32 v5, v64, v65, v66
    v_max3_f32 v5, v5, v67, v68
    v_max3_f32 v5, v5, v69, v70
    v_max3_f32 v5, v5, v71, v72
    v_mfma_f32_32x32x16_bf16 v[208:223], a[36:39], v[128:131], v[208:223]
    ds_read_b64_tr_b16 a[52:53], v14 offset:4096
    ds_read_b64_tr_b16 a[54:55], v14 offset:5120
    v_max3_f32 v5, v5, v73, v74
    v_max3_f32 v5, v5, v75, v76
    v_max3_f32 v5, v5, v77, v78
    v_max_f32 v5, v5, v79
    v_max3_f32 v6, v80, v81, v82
    s_waitcnt lgkmcnt(4)
    v_mfma_f32_32x32x16_bf16 v[224:239], a[40:43], v[128:131], v[224:239]
    ds_read_b64_tr_b16 a[56:57], v15 offset:4096
    ds_read_b64_tr_b16 a[58:59], v15 offset:5120
    v_max3_f32 v6, v6, v83, v84
    v_max3_f32 v6, v6, v85, v86
    v_max3_f32 v6, v6, v87, v88
    v_max3_f32 v6, v6, v89, v90
    v_mfma_f32_32x32x16_bf16 v[240:255], a[44:47], v[128:131], v[240:255]
    ds_read_b64_tr_b16 a[60:61], v16 offset:4096
    ds_read_b64_tr_b16 a[62:63], v16 offset:5120
    v_max3_f32 v6, v6, v91, v92
    v_max3_f32 v6, v6, v93, v94
    v_max_f32 v6, v6, v95
    v_max3_f32 v7, v96, v97, v98
    v_max3_f32 v7, v7, v99, v100
    s_waitcnt lgkmcnt(4)
    v_mfma_f32_32x32x16_bf16 v[192:207], a[48:51], v[132:135], v[192:207]
    ds_read_b64_tr_b16 a[32:33], v13 offset:8192
    ds_read_b64_tr_b16 a[34:35], v13 offset:9216
    v_max3_f32 v7, v7, v101, v102
    v_max3_f32 v7, v7, v103, v104
    v_max3_f32 v7, v7, v105, v106
    v_max3_f32 v7, v7, v107, v108
    v_mfma_f32_32x32x16_bf16 v[208:223], a[52:55], v[132:135], v[208:223]
    ds_read_b64_tr_b16 a[36:37], v14 offset:8192
    ds_read_b64_tr_b16 a[38:39], v14 offset:9216
    v_max3_f32 v7, v7, v109, v110
    v_max_f32 v7, v7, v111
    v_max3_f32 v8, v112, v113, v114
    v_max3_f32 v8, v8, v115, v116
    s_waitcnt lgkmcnt(4)
    v_mfma_f32_32x32x16_bf16 v[224:239], a[56:59], v[132:135], v[224:239]
    ds_read_b64_tr_b16 a[40:41], v15 offset:8192
    ds_read_b64_tr_b16 a[42:43], v15 offset:9216
    v_max3_f32 v8, v8, v117, v118
    v_max3_f32 v8, v8, v119, v120
    v_max3_f32 v8, v8, v121, v122
    v_max3_f32 v8, v8, v123, v124
    v_max3_f32 v8, v8, v125, v126
    v_mfma_f32_32x32x16_bf16 v[240:255], a[60:63], v[132:135], v[240:255]
    ds_read_b64_tr_b16 a[44:45], v16 offset:8192
    ds_read_b64_tr_b16 a[46:47], v16 offset:9216
    v_max_f32 v8, v8, v127
    v_max3_f32 v5, v5, v6, v7
    v_max_f32 v5, v5, v8
    v_cmp_lt_f32 vcc, s52, v5
    s_waitcnt lgkmcnt(4)
    v_mfma_f32_32x32x16_bf16 v[192:207], a[32:35], v[136:139], v[192:207]
    ds_read_b64_tr_b16 a[48:49], v13 offset:12288
    ds_read_b64_tr_b16 a[50:51], v13 offset:13312
    v_mfma_f32_32x32x16_bf16 v[208:223], a[36:39], v[136:139], v[208:223]
    ds_read_b64_tr_b16 a[52:53], v14 offset:12288
    ds_read_b64_tr_b16 a[54:55], v14 offset:13312
    s_cbranch_vccnz L_raise1
L_raise1_back:
    s_waitcnt lgkmcnt(4)
    v_mfma_f32_32x32x16_bf16 v[224:239], a[40:43], v[136:139], v[224:239]
    ds_read_b64_tr_b16 a[56:57], v15 offset:12288
    ds_read_b64_tr_b16 a[58:59], v15 offset:13312
    v_exp_f32 v64, v64
    v_exp_f32 v65, v65
    v_mfma_f32_32x32x16_bf16 v[240:255], a[44:47], v[136:139], v[240:255]
    ds_read_b64_tr_b16 a[60:61], v16 offset:12288
    ds_read_b64_tr_b16 a[62:63], v16 offset:13312
    v_exp_f32 v66, v66
    v_exp_f32 v67, v67
    s_waitcnt lgkmcnt(4)
    v_mfma_f32_32x32x16_bf16 v[192:207], a[48:51], v[140:143], v[192:207]
    ds_read_b64_tr_b16 a[32:33], v13 offset:16384
    ds_read_b64_tr_b16 a[34:35], v13 offset:17408
    v_exp_f32 v68, v68
    v_exp_f32 v69, v69
    v_mfma_f32_32x32x16_bf16 v[208:223], a[52:55], v[140:143], v[208:223]
    ds_read_b64_tr_b16 a[36:37], v14 offset:16384
    ds_read_b64_tr_b16 a[38:39], v14 offset:17408
    v_exp_f32 v70, v70
    s_waitcnt lgkmcnt(4)
    v_mfma_f32_32x32x16_bf16 v[224:239], a[56:59], v[140:143], v[224:239]
    ds_read_b64_tr_b16 a[40:41], v15 offset:16384
    ds_read_b64_tr_b16 a[42:43], v15 offset:17408
    v_exp_f32 v71, v71
    v_add_f32 v2, v2, v64
    v_mfma_f32_32x32x16_bf16 v[240:255], a[60:63], v[140:143], v[240:255]
    ds_read_b64_tr_b16 a[44:45], v16 offset:16384
    ds_read_b64_tr_b16 a[46:47], v16 offset:17408
    v_add_f32 v9, v9, v65
    v_add_f32 v10, v10, v66
    v_add_f32 v11, v11, v67
    s_waitcnt vmcnt(8)
    s_barrier
    s_waitcnt lgkmcnt(4)
    v_mfma_f32_32x32x16_bf16 v[192:207], a[32:35], v[144:147], v[192:207]
    ds_read_b64_tr_b16 a[48:49], v13 offset:20480
    ds_read_b64_tr_b16 a[50:51], v13 offset:21504
    v_exp_f32 v72, v72
    v_exp_f32 v73, v73
    v_mfma_f32_32x32x16_bf16 v[208:223], a[36:39], v[144:147], v[208:223]
    ds_read_b64_tr_b16 a[52:53], v14 offset:20480
    ds_read_b64_tr_b16 a[54:55], v14 offset:21504
    s_lshl_b32 s47, s24, 13
    s_add_u32 s47, s47, 0
    s_add_u32 m0, s54, s47
    s_add_u32 s47, s47, s50
    buffer_load_dwordx4 v25, s[12:15], s47 offen nt lds
    v_exp_f32 v74, v74
    v_exp_f32 v75, v75
    v_add_f32 v2, v2, v68
    s_waitcnt lgkmcnt(4)
    v_mfma_f32_32x32x16_bf16 v[224:239], a[40:43], v[144:147], v[224:239]
    ds_read_b64_tr_b16 a[56:57], v15 offset:20480
    ds_read_b64_tr_b16 a[58:59], v15 offset:21504
    buffer_load_dwordx4 v26, s[12:15], s47 offen offset:1024 nt lds
    v_add_f32 v9, v9, v69
    v_add_f32 v10, v10, v70
    v_add_f32 v11, v11, v71
    v_cvt_pk_bf16_f32 v128, v64, v65
    v_cvt_pk_bf16_f32 v129, v66, v67
    v_mfma_f32_32x32x16_bf16 v[240:255], a[44:47], v[144:147], v[240:255]
    ds_read_b64_tr_b16 a[60:61], v16 offset:20480
    ds_read_b64_tr_b16 a[62:63], v16 offset:21504
    v_cvt_pk_bf16_f32 v130, v68, v69
    v_cvt_pk_bf16_f32 v131, v70, v71
    v_exp_f32 v76, v76
    s_waitcnt lgkmcnt(4)
    v_mfma_f32_32x32x16_bf16 v[192:207], a[48:51], v[148:151], v[192:207]
    ds_read_b64_tr_b16 a[32:33], v13 offset:24576
    ds_read_b64_tr_b16 a[34:35], v13 offset:25600
    buffer_load_dwordx4 v27, s[12:15], s47 offen offset:2048 nt lds
    v_exp_f32 v77, v77
    v_exp_f32 v78, v78
    v_mfma_f32_32x32x16_bf16 v[208:223], a[52:55], v[148:151], v[208:223]
    ds_read_b64_tr_b16 a[36:37], v14 offset:24576
    ds_read_b64_tr_b16 a[38:39], v14 offset:25600
    v_exp_f32 v79, v79
    v_add_f32 v2, v2, v72
    v_add_f32 v9, v9, v73
    v_add_f32 v10, v10, v74
    s_waitcnt lgkmcnt(4)
    v_mfma_f32_32x32x16_bf16 v[224:239], a[56:59], v[148:151], v[224:239]
    ds_read_b64_tr_b16 a[40:41], v15 offset:24576
    ds_read_b64_tr_b16 a[42:43], v15 offset:25600
    buffer_load_dwordx4 v28, s[12:15], s47 offen offset:3072 nt lds
    v_add_f32 v11, v11, v75
    v_cvt_pk_bf16_f32 v132, v72, v73
    v_cvt_pk_bf16_f32 v133, v74, v75
    v_add_f32 v2, v2, v76
    v_add_f32 v9, v9, v77
    v_mfma_f32_32x32x16_bf16 v[240:255], a[60:63], v[148:151], v[240:255]
    ds_read_b64_tr_b16 a[44:45], v16 offset:24576
    ds_read_b64_tr_b16 a[46:47], v16 offset:25600
    v_add_f32 v10, v10, v78
    v_add_f32 v11, v11, v79
    v_cvt_pk_bf16_f32 v134, v76, v77
    v_cvt_pk_bf16_f32 v135, v78, v79
    s_waitcnt lgkmcnt(4)
    v_mfma_f32_32x32x16_bf16 v[192:207], a[32:35], v[152:155], v[192:207]
    ds_read_b64_tr_b16 a[48:49], v13 offset:28672
    ds_read_b64_tr_b16 a[50:51], v13 offset:29696
    v_mfma_f32_32x32x16_bf16 v[208:223], a[36:39], v[152:155], v[208:223]
    ds_read_b64_tr_b16 a[52:53], v14 offset:28672
    ds_read_b64_tr_b16 a[54:55], v14 offset:29696
    s_waitcnt lgkmcnt(4)
    v_mfma_f32_32x32x16_bf16 v[224:239], a[40:43], v[152:155], v[224:239]
    ds_read_b64_tr_b16 a[56:57], v15 offset:28672
    ds_read_b64_tr_b16 a[58:59], v15 offset:29696
    v_mfma_f32_32x32x16_bf16 v[240:255], a[44:47], v[152:155], v[240:255]
    ds_read_b64_tr_b16 a[60:61], v16 offset:28672
    ds_read_b64_tr_b16 a[62:63], v16 offset:29696
    s_waitcnt lgkmcnt(4)
    v_mfma_f32_32x32x16_bf16 v[192:207], a[48:51], v[156:159], v[192:207]
    ds_read_b128 a[0:3], v17 offset:0
    ds_read_b128 a[4:7], v18 offset:0
    v_mfma_f32_32x32x16_bf16 v[208:223], a[52:55], v[156:159], v[208:223]
    ds_read_b128 a[8:11], v19 offset:0
    ds_read_b128 a[12:15], v20 offset:0
    s_waitcnt lgkmcnt(4)
    v_mfma_f32_32x32x16_bf16 v[224:239], a[56:59], v[156:159], v[224:239]
    ds_read_b128 a[16:19], v21 offset:0
    ds_read_b128 a[20:23], v22 offset:0
    v_mfma_f32_32x32x16_bf16 v[240:255], a[60:63], v[156:159], v[240:255]
    v_add_u32 v13, 65536, v13
    v_add_u32 v14, 65536, v14
    v_add_u32 v15, 65536, v15
    v_add_u32 v16, 65536, v16
    s_cmp_lg_u32 s98, 0
    s_cbranch_scc1 L_rs_a1
L_rs_a1_back:
    s_waitcnt lgkmcnt(4)
    v_mfma_f32_32x32x16_bf16 v[64:79], a[0:3], v[32:35], v[176:191]
    ds_read_b128 a[24:27], v23 offset:0
    ds_read_b128 a[28:31], v24 offset:0
    v_exp_f32 v80, v80
    v_exp_f32 v81, v81
    v_exp_f32 v82, v82
    v_exp_f32 v83, v83
    v_mfma_f32_32x32x16_bf16 v[64:79], a[4:7], v[36:39], v[64:79]
    v_exp_f32 v84, v84
    v_exp_f32 v85, v85
    v_exp_f32 v86, v86
    s_waitcnt lgkmcnt(4)
    v_mfma_f32_32x32x16_bf16 v[64:79], a[8:11], v[40:43], v[64:79]
    ds_read_b128 a[0:3], v17 offset:8192
    ds_read_b128 a[4:7], v18 offset:8192
    v_exp_f32 v87, v87
    v_add_f32 v2, v2, v80
    v_add_f32 v9, v9, v81
    v_add_f32 v10, v10, v82
    v_add_f32 v11, v11, v83
    v_exp_f32 v88, v88
    v_mfma_f32_32x32x16_bf16 v[64:79], a[12:15], v[44:47], v[64:79]
    v_exp_f32 v89, v89
    v_exp_f32 v90, v90
    v_exp_f32 v91, v91
    s_waitcnt lgkmcnt(4)
    v_mfma_f32_32x32x16_bf16 v[64:79], a[16:19], v[48:51], v[64:79]
    ds_read_b128 a[8:11], v19 offset:8192
    ds_read_b128 a[12:15], v20 offset:8192
    v_add_f32 v2, v2, v84
    v_add_f32 v9, v9, v85
    v_add_f32 v10, v10, v86
    v_add_f32 v11, v11, v87
    v_cvt_pk_bf16_f32 v136, v80, v81
    v_cvt_pk_bf16_f32 v137, v82, v83
    v_cvt_pk_bf16_f32 v138, v84, v85
    v_mfma_f32_32x32x16_bf16 v[64:79], a[20:23], v[52:55], v[64:79]
    v_cvt_pk_bf16_f32 v139, v86, v87
    v_exp_f32 v92, v92
    v_exp_f32 v93, v93
    v_exp_f32 v94, v94
    s_waitcnt lgkmcnt(4)
    v_mfma_f32_32x32x16_bf16 v[64:79], a[24:27], v[56:59], v[64:79]
    ds_read_b128 a[16:19], v21 offset:8192
    ds_read_b128 a[20:23], v22 offset:8192
    v_exp_f32 v95, v95
    v_add_f32 v2, v2, v88
    v_add_f32 v9, v9, v89
    v_add_f32 v10, v10, v90
    v_add_f32 v11, v11, v91
    v_cvt_pk_bf16_f32 v140, v88, v89
    v_mfma_f32_32x32x16_bf16 v[64:79], a[28:31], v[60:63], v[64:79]
    v_cvt_pk_bf16_f32 v141, v90, v91
    v_add_f32 v2, v2, v92
    v_add_f32 v9, v9, v93
    v_add_f32 v10, v10, v94
    v_add_f32 v11, v11, v95
    v_cvt_pk_bf16_f32 v142, v92, v93
    v_cvt_pk_bf16_f32 v143, v94, v95
    s_waitcnt lgkmcnt(4)
    v_mfma_f32_32x32x16_bf16 v[80:95], a[0:3], v[32:35], v[176:191]
    ds_read_b128 a[24:27], v23 offset:8192
    ds_read_b128 a[28:31], v24 offset:8192
    v_exp_f32 v96, v96
    v_exp_f32 v97, v97
    v_exp_f32 v98, v98
    v_exp_f32 v99, v99
    v_mfma_f32_32x32x16_bf16 v[80:95], a[4:7], v[36:39], v[80:95]
    v_exp_f32 v100, v100
    v_exp_f32 v101, v101
    v_exp_f32 v102, v102
    s_waitcnt lgkmcnt(4)
    v_mfma_f32_32x32x16_bf16 v[80:95], a[8:11], v[40:43], v[80:95]
    ds_read_b128 a[0:3], v17 offset:16384
    ds_read_b128 a[4:7], v18 offset:16384
    v_exp_f32 v103, v103
    v_add_f32 v2, v2, v96
    v_add_f32 v9, v9, v97
    v_add_f32 v10, v10, v98
    v_add_f32 v11, v11, v99
    v_exp_f32 v104, v104
    v_mfma_f32_32x32x16_bf16 v[80:95], a[12:15], v[44:47], v[80:95]
    v_exp_f32 v105, v105
    v_exp_f32 v106, v106
    v_exp_f32 v107, v107
    s_waitcnt lgkmcnt(4)
    v_mfma_f32_32x32x16_bf16 v[80:95], a[16:19], v[48:51], v[80:95]
    ds_read_b128 a[8:11], v19 offset:16384
    ds_read_b128 a[12:15], v20 offset:16384
    v_add_f32 v2, v2, v100
    v_add_f32 v9, v9, v101
    v_add_f32 v10, v10, v102
    v_add_f32 v11, v11, v103
    v_cvt_pk_bf16_f32 v144, v96, v97
    v_cvt_pk_bf16_f32 v145, v98, v99
    v_cvt_pk_bf16_f32 v146, v100, v101
    v_mfma_f32_32x32x16_bf16 v[80:95], a[20:23], v[52:55], v[80:95]
    v_cvt_pk_bf16_f32 v147, v102, v103
    v_exp_f32 v108, v108
    v_exp_f32 v109, v109
    v_exp_f32 v110, v110
    s_waitcnt lgkmcnt(4)
    v_mfma_f32_32x32x16_bf16 v[80:95], a[24:27], v[56:59], v[80:95]
    ds_read_b128 a[16:19], v21 offset:16384
    ds_read_b128 a[20:23], v22 offset:16384
    v_exp_f32 v111, v111
    v_add_f32 v2, v2, v104
    v_add_f32 v9, v9, v105
    v_add_f32 v10, v10, v106
    v_add_f32 v11, v11, v107
    v_cvt_pk_bf16_f32 v148, v104, v105
    v_mfma_f32_32x32x16_bf16 v[80:95], a[28:31], v[60:63], v[80:95]
    v_cvt_pk_bf16_f32 v149, v106, v107
    v_add_f32 v2, v2, v108
    v_add_f32 v9, v9, v109
    v_add_f32 v10, v10, v110
    v_add_f32 v11, v11, v111
    v_cvt_pk_bf16_f32 v150, v108, v109
    v_cvt_pk_bf16_f32 v151, v110, v111
    s_waitcnt vmcnt(4)
    s_barrier
    s_waitcnt lgkmcnt(4)
    v_mfma_f32_32x32x16_bf16 v[96:111], a[0:3], v[32:35], v[176:191]
    ds_read_b128 a[24:27], v23 offset:16384
    ds_read_b128 a[28:31], v24 offset:16384
    v_exp_f32 v112, v112
    v_exp_f32 v113, v113
    v_exp_f32 v114, v114
    v_exp_f32 v115, v115
    v_mfma_f32_32x32x16_bf16 v[96:111], a[4:7], v[36:39], v[96:111]
    s_lshl_b32 s47, s24, 13
    s_add_u32 s47, s47, 4096
    s_add_u32 m0, s54, s47
    s_add_u32 s47, s47, s50
    buffer_load_dwordx4 v25, s[12:15], s47 offen nt lds
    v_exp_f32 v116, v116
    v_exp_f32 v117, v117
    v_exp_f32 v118, v118
    s_waitcnt lgkmcnt(4)
    v_mfma_f32_32x32x16_bf16 v[96:111], a[8:11], v[40:43], v[96:111]
    ds_read_b128 a[0:3], v17 offset:24576
    ds_read_b128 a[4:7], v18 offset:24576
    buffer_load_dwordx4 v26, s[12:15], s47 offen offset:1024 nt lds
    v_exp_f32 v119, v119
    v_add_f32 v2, v2, v112
    v_add_f32 v9, v9, v113
    v_add_f32 v10, v10, v114
    v_add_f32 v11, v11, v115
    v_exp_f32 v120, v120
    v_mfma_f32_32x32x16_bf16 v[96:111], a[12:15], v[44:47], v[96:111]
    buffer_load_dwordx4 v27, s[12:15], s47 offen offset:2048 nt lds
    v_exp_f32 v121, v121
    v_exp_f32 v122, v122
    v_exp_f32 v123, v123
    s_waitcnt lgkmcnt(4)
    v_mfma_f32_32x32x16_bf16 v[96:111], a[16:19], v[48:51], v[96:111]
    ds_read_b128 a[8:11], v19 offset:24576
    ds_read_b128 a[12:15], v20 offset:24576
    v_add_f32 v2, v2, v116
    v_add_f32 v9, v9, v117
    v_add_f32 v10, v10, v118
    v_add_f32 v11, v11, v119
    v_cvt_pk_bf16_f32 v152, v112, v113
    v_cvt_pk_bf16_f32 v153, v114, v115
    v_cvt_pk_bf16_f32 v154, v116, v117
    v_mfma_f32_32x32x16_bf16 v[96:111], a[20:23], v[52:55], v[96:111]
    buffer_load_dwordx4 v28, s[12:15], s47 offen offset:3072 nt lds
    v_cvt_pk_bf16_f32 v155, v118, v119
    v_exp_f32 v124, v124
    v_exp_f32 v125, v125
    v_exp_f32 v126, v126
    s_waitcnt lgkmcnt(4)
    v_mfma_f32_32x32x16_bf16 v[96:111], a[24:27], v[56:59], v[96:111]
    ds_read_b128 a[16:19], v21 offset:24576
    ds_read_b128 a[20:23], v22 offset:24576
    s_add_u32 s54, s54, 32768
    s_cmp_eq_u32 s54, 163840
    s_cselect_b32 s54, 0, s54
    s_add_u32 s50, s50, 32768
    v_exp_f32 v127, v127
    v_add_f32 v2, v2, v120
    v_add_f32 v9, v9, v121
    v_add_f32 v10, v10, v122
    v_add_f32 v11, v11, v123
    v_cvt_pk_bf16_f32 v156, v120, v121
    v_mfma_f32_32x32x16_bf16 v[96:111], a[28:31], v[60:63], v[96:111]
    v_cvt_pk_bf16_f32 v157, v122, v123
    v_add_f32 v2, v2, v124
    v_add_f32 v9, v9, v125
    v_add_f32 v10, v10, v126
    v_add_f32 v11, v11, v127
    v_cvt_pk_bf16_f32 v158, v124, v125
    v_cvt_pk_bf16_f32 v159, v126, v127
    s_waitcnt lgkmcnt(4)
    v_mfma_f32_32x32x16_bf16 v[112:127], a[0:3], v[32:35], v[176:191]
    ds_read_b128 a[24:27], v23 offset:24576
    ds_read_b128 a[28:31], v24 offset:24576
    v_mfma_f32_32x32x16_bf16 v[112:127], a[4:7], v[36:39], v[112:127]
    s_waitcnt lgkmcnt(4)
    v_mfma_f32_32x32x16_bf16 v[112:127], a[8:11], v[40:43], v[112:127]
    ds_read_b64_tr_b16 a[32:33], v13 offset:0
    ds_read_b64_tr_b16 a[34:35], v13 offset:1024
    v_mfma_f32_32x32x16_bf16 v[112:127], a[12:15], v[44:47], v[112:127]
    ds_read_b64_tr_b16 a[36:37], v14 offset:0
    ds_read_b64_tr_b16 a[38:39], v14 offset:1024
    s_waitcnt lgkmcnt(6)
    v_mfma_f32_32x32x16_bf16 v[112:127], a[16:19], v[48:51], v[112:127]
    ds_read_b64_tr_b16 a[40:41], v15 offset:0
    ds_read_b64_tr_b16 a[42:43], v15 offset:1024
    v_mfma_f32_32x32x16_bf16 v[112:127], a[20:23], v[52:55], v[112:127]
    ds_read_b64_tr_b16 a[44:45], v16 offset:0
    ds_read_b64_tr_b16 a[46:47], v16 offset:1024
    s_waitcnt lgkmcnt(8)
    v_mfma_f32_32x32x16_bf16 v[112:127], a[24:27], v[56:59], v[112:127]
    v_mfma_f32_32x32x16_bf16 v[112:127], a[28:31], v[60:63], v[112:127]
    v_add_u32 v17, 65536, v17
    v_add_u32 v18, 65536, v18
    v_add_u32 v19, 65536, v19
    v_add_u32 v20, 65536, v20
    v_add_u32 v21, 65536, v21
    v_add_u32 v22, 65536, v22
    v_add_u32 v23, 65536, v23
    v_add_u32 v24, 65536, v24
    s_waitcnt lgkmcnt(4)
    v_mfma_f32_32x32x16_bf16 v[192:207], a[32:35], v[128:131], v[192:207]
    ds_read_b64_tr_b16 a[48:49], v13 offset:4096
    ds_read_b64_tr_b16 a[50:51], v13 offset:5120
    v_max3_f32 v5, v64, v65, v66
    v_max3_f32 v5, v5, v67, v68
    v_max3_f32 v5, v5, v69, v70
    v_max3_f32 v5, v5, v71, v72
    v_mfma_f32_32x32x16_bf16 v[208:223], a[36:39], v[128:131], v[208:223]
    ds_read_b64_tr_b16 a[52:53], v14 offset:4096
    ds_read_b64_tr_b16 a[54:55], v14 offset:5120
    s_lshl_b32 s47, s24, 13
    s_add_u32 s47, s47, 0
    s_add_u32 m0, s54, s47
    s_add_u32 s47, s47, s51
    buffer_load_dwordx4 v29, s[16:19], s47 offen nt lds
    v_max3_f32 v5, v5, v73, v74
    v_max3_f32 v5, v5, v75, v76
    v_max3_f32 v5, v5, v77, v78
    v_max_f32 v5, v5, v79
    v_max3_f32 v6, v80, v81, v82
    s_waitcnt lgkmcnt(4)
    v_mfma_f32_32x32x16_bf16 v[224:239], a[40:43], v[128:131], v[224:239]
    ds_read_b64_tr_b16 a[56:57], v15 offset:4096
    ds_read_b64_tr_b16 a[58:59], v15 offset:5120
    buffer_load_dwordx4 v29, s[16:19], s47 offen offset:1024 nt lds
    v_max3_f32 v6, v6, v83, v84
    v_max3_f32 v6, v6, v85, v86
    v_max3_f32 v6, v6, v87, v88
    v_max3_f32 v6, v6, v89, v90
    v_mfma_f32_32x32x16_bf16 v[240:255], a[44:47], v[128:131], v[240:255]
    ds_read_b64_tr_b16 a[60:61], v16 offset:4096
    ds_read_b64_tr_b16 a[62:63], v16 offset:5120
    v_max3_f32 v6, v6, v91, v92
    v_max3_f32 v6, v6, v93, v94
    v_max_f32 v6, v6, v95
    v_max3_f32 v7, v96, v97, v98
    v_max3_f32 v7, v7, v99, v100
    s_waitcnt lgkmcnt(4)
    v_mfma_f32_32x32x16_bf16 v[192:207], a[48:51], v[132:135], v[192:207]
    ds_read_b64_tr_b16 a[32:33], v13 offset:8192
    ds_read_b64_tr_b16 a[34:35], v13 offset:9216
    buffer_load_dwordx4 v29, s[16:19], s47 offen offset:2048 nt lds
    v_max3_f32 v7, v7, v101, v102
    v_max3_f32 v7, v7, v103, v104
    v_max3_f32 v7, v7, v105, v106
    v_max3_f32 v7, v7, v107, v108
    v_mfma_f32_32x32x16_bf16 v[208:223], a[52:55], v[132:135], v[208:223]
    ds_read_b64_tr_b16 a[36:37], v14 offset:8192
    ds_read_b64_tr_b16 a[38:39], v14 offset:9216
    v_max3_f32 v7, v7, v109, v110
    v_max_f32 v7, v7, v111
    v_max3_f32 v8, v112, v113, v114
    v_max3_f32 v8, v8, v115, v116
    s_waitcnt lgkmcnt(4)
    v_mfma_f32_32x32x16_bf16 v[224:239], a[56:59], v[132:135], v[224:239]
    ds_read_b64_tr_b16 a[40:41], v15 offset:8192
    ds_read_b64_tr_b16 a[42:43], v15 offset:9216
    buffer_load_dwordx4 v29, s[16:19], s47 offen offset:3072 nt lds
    v_max3_f32 v8, v8, v117, v118
    v_max3_f32 v8, v8, v119, v120
    v_max3_f32 v8, v8, v121, v122
    v_max3_f32 v8, v8, v123, v124
    v_max3_f32 v8, v8, v125, v126
    v_mfma_f32_32x32x16_bf16 v[240:255], a[60:63], v[132:135], v[240:255]
    ds_read_b64_tr_b16 a[44:45], v16 offset:8192
    ds_read_b64_tr_b16 a[46:47], v16 offset:9216
    v_max_f32 v8, v8, v127
    v_max3_f32 v5, v5, v6, v7
    v_max_f32 v5, v5, v8
    v_cmp_lt_f32 vcc, s52, v5
    s_waitcnt lgkmcnt(4)
    v_mfma_f32_32x32x16_bf16 v[192:207], a[32:35], v[136:139], v[192:207]
    ds_read_b64_tr_b16 a[48:49], v13 offset:12288
    ds_read_b64_tr_b16 a[50:51], v13 offset:13312
    v_mfma_f32_32x32x16_bf16 v[208:223], a[36:39], v[136:139], v[208:223]
    ds_read_b64_tr_b16 a[52:53], v14 offset:12288
    ds_read_b64_tr_b16 a[54:55], v14 offset:13312
    s_cbranch_vccnz L_raise2
L_raise2_back:
    s_waitcnt lgkmcnt(4)
    v_mfma_f32_32x32x16_bf16 v[224:239], a[40:43], v[136:139], v[224:239]
    ds_read_b64_tr_b16 a[56:57], v15 offset:12288
    ds_read_b64_tr_b16 a[58:59], v15 offset:13312
    v_exp_f32 v64, v64
    v_exp_f32 v65, v65
    v_mfma_f32_32x32x16_bf16 v[240:255], a[44:47], v[136:139], v[240:255]
    ds_read_b64_tr_b16 a[60:61], v16 offset:12288
    ds_read_b64_tr_b16 a[62:63], v16 offset:13312
    v_exp_f32 v66, v66
    v_exp_f32 v67, v67
    s_waitcnt lgkmcnt(4)
    v_mfma_f32_32x32x16_bf16 v[192:207], a[48:51], v[140:143], v[192:207]
    ds_read_b64_tr_b16 a[32:33], v13 offset:16384
    ds_read_b64_tr_b16 a[34:35], v13 offset:17408
    v_exp_f32 v68, v68
    v_exp_f32 v69, v69
    v_mfma_f32_32x32x16_bf16 v[208:223], a[52:55], v[140:143], v[208:223]
    ds_read_b64_tr_b16 a[36:37], v14 offset:16384
    ds_read_b64_tr_b16 a[38:39], v14 offset:17408
    v_exp_f32 v70, v70
    s_waitcnt lgkmcnt(4)
    v_mfma_f32_32x32x16_bf16 v[224:239], a[56:59], v[140:143], v[224:239]
    ds_read_b64_tr_b16 a[40:41], v15 offset:16384
    ds_read_b64_tr_b16 a[42:43], v15 offset:17408
    v_exp_f32 v71, v71
    v_add_f32 v2, v2, v64
    v_mfma_f32_32x32x16_bf16 v[240:255], a[60:63], v[140:143], v[240:255]
    ds_read_b64_tr_b16 a[44:45], v16 offset:16384
    ds_read_b64_tr_b16 a[46:47], v16 offset:17408
    v_add_f32 v9, v9, v65
    v_add_f32 v10, v10, v66
    v_add_f32 v11, v11, v67
    s_waitcnt vmcnt(4)
    s_barrier
    s_waitcnt lgkmcnt(4)
    v_mfma_f32_32x32x16_bf16 v[192:207], a[32:35], v[144:147], v[192:207]
    ds_read_b64_tr_b16 a[48:49], v13 offset:20480
    ds_read_b64_tr_b16 a[50:51], v13 offset:21504
    v_exp_f32 v72, v72
    v_exp_f32 v73, v73
    v_mfma_f32_32x32x16_bf16 v[208:223], a[36:39], v[144:147], v[208:223]
    ds_read_b64_tr_b16 a[52:53], v14 offset:20480
    ds_read_b64_tr_b16 a[54:55], v14 offset:21504
    s_lshl_b32 s47, s24, 13
    s_add_u32 s47, s47, 4096
    s_add_u32 m0, s54, s47
    s_add_u32 s47, s47, s51
    buffer_load_dwordx4 v29, s[16:19], s47 offen nt lds
    v_exp_f32 v74, v74
    v_exp_f32 v75, v75
    v_add_f32 v2, v2, v68
    s_waitcnt lgkmcnt(4)
    v_mfma_f32_32x32x16_bf16 v[224:239], a[40:43], v[144:147], v[224:239]
    ds_read_b64_tr_b16 a[56:57], v15 offset:20480
    ds_read_b64_tr_b16 a[58:59], v15 offset:21504
    buffer_load_dwordx4 v29, s[16:19], s47 offen offset:1024 nt lds
    v_add_f32 v9, v9, v69
    v_add_f32 v10, v10, v70
    v_add_f32 v11, v11, v71
    v_cvt_pk_bf16_f32 v128, v64, v65
    v_cvt_pk_bf16_f32 v129, v66, v67
    v_mfma_f32_32x32x16_bf16 v[240:255], a[44:47], v[144:147], v[240:255]
    ds_read_b64_tr_b16 a[60:61], v16 offset:20480
    ds_read_b64_tr_b16 a[62:63], v16 offset:21504
    buffer_load_dwordx4 v29, s[16:19], s47 offen offset:2048 nt lds
    v_cvt_pk_bf16_f32 v130, v68, v69
    v_cvt_pk_bf16_f32 v131, v70, v71
    v_exp_f32 v76, v76
    s_waitcnt lgkmcnt(4)
    v_mfma_f32_32x32x16_bf16 v[192:207], a[48:51], v[148:151], v[192:207]
    ds_read_b64_tr_b16 a[32:33], v13 offset:24576
    ds_read_b64_tr_b16 a[34:35], v13 offset:25600
    v_exp_f32 v77, v77
    v_exp_f32 v78, v78
    v_mfma_f32_32x32x16_bf16 v[208:223], a[52:55], v[148:151], v[208:223]
    ds_read_b64_tr_b16 a[36:37], v14 offset:24576
    ds_read_b64_tr_b16 a[38:39], v14 offset:25600
    buffer_load_dwordx4 v29, s[16:19], s47 offen offset:3072 nt lds
    v_exp_f32 v79, v79
    v_add_f32 v2, v2, v72
    v_add_f32 v9, v9, v73
    v_add_f32 v10, v10, v74
    s_waitcnt lgkmcnt(4)
    v_mfma_f32_32x32x16_bf16 v[224:239], a[56:59], v[148:151], v[224:239]
    ds_read_b64_tr_b16 a[40:41], v15 offset:24576
    ds_read_b64_tr_b16 a[42:43], v15 offset:25600
    s_add_u32 s54, s54, 32768
    s_cmp_eq_u32 s54, 163840
    s_cselect_b32 s54, 0, s54
    s_add_u32 s51, s51, 32768
    v_add_f32 v11, v11, v75
    v_cvt_pk_bf16_f32 v132, v72, v73
    v_cvt_pk_bf16_f32 v133, v74, v75
    v_add_f32 v2, v2, v76
    v_add_f32 v9, v9, v77
    v_mfma_f32_32x32x16_bf16 v[240:255], a[60:63], v[148:151], v[240:255]
    ds_read_b64_tr_b16 a[44:45], v16 offset:24576
    ds_read_b64_tr_b16 a[46:47], v16 offset:25600
    v_add_f32 v10, v10, v78
    v_add_f32 v11, v11, v79
    v_cvt_pk_bf16_f32 v134, v76, v77
    v_cvt_pk_bf16_f32 v135, v78, v79
    s_waitcnt lgkmcnt(4)
    v_mfma_f32_32x32x16_bf16 v[192:207], a[32:35], v[152:155], v[192:207]
    ds_read_b64_tr_b16 a[48:49], v13 offset:28672
    ds_read_b64_tr_b16 a[50:51], v13 offset:29696
    v_mfma_f32_32x32x16_bf16 v[208:223], a[36:39], v[152:155], v[208:223]
    ds_read_b64_tr_b16 a[52:53], v14 offset:28672
    ds_read_b64_tr_b16 a[54:55], v14 offset:29696
    s_waitcnt lgkmcnt(4)
    v_mfma_f32_32x32x16_bf16 v[224:239], a[40:43], v[152:155], v[224:239]
    ds_read_b64_tr_b16 a[56:57], v15 offset:28672
    ds_read_b64_tr_b16 a[58:59], v15 offset:29696
    v_mfma_f32_32x32x16_bf16 v[240:255], a[44:47], v[152:155], v[240:255]
    ds_read_b64_tr_b16 a[60:61], v16 offset:28672
    ds_read_b64_tr_b16 a[62:63], v16 offset:29696
    s_waitcnt lgkmcnt(4)
    v_mfma_f32_32x32x16_bf16 v[192:207], a[48:51], v[156:159], v[192:207]
    ds_read_b128 a[0:3], v17 offset:0
    ds_read_b128 a[4:7], v18 offset:0
    v_mfma_f32_32x32x16_bf16 v[208:223], a[52:55], v[156:159], v[208:223]
    ds_read_b128 a[8:11], v19 offset:0
    ds_read_b128 a[12:15], v20 offset:0
    s_waitcnt lgkmcnt(4)
    v_mfma_f32_32x32x16_bf16 v[224:239], a[56:59], v[156:159], v[224:239]
    ds_read_b128 a[16:19], v21 offset:0
    ds_read_b128 a[20:23], v22 offset:0
    v_mfma_f32_32x32x16_bf16 v[240:255], a[60:63], v[156:159], v[240:255]
    v_add_u32 v13, 65536, v13
    v_add_u32 v14, 65536, v14
    v_add_u32 v15, 65536, v15
    v_add_u32 v16, 65536, v16
    s_cmp_lg_u32 s98, 0
    s_cbranch_scc1 L_rs_a2
L_rs_a2_back:
    s_waitcnt lgkmcnt(4)
    v_mfma_f32_32x32x16_bf16 v[64:79], a[0:3], v[32:35], v[176:191]
    ds_read_b128 a[24:27], v23 offset:0
    ds_read_b128 a[28:31], v24 offset:0
    v_exp_f32 v80, v80
    v_exp_f32 v81, v81
    v_exp_f32 v82, v82
    v_exp_f32 v83, v83
    v_mfma_f32_32x32x16_bf16 v[64:79], a[4:7], v[36:39], v[64:79]
    s_lshl_b32 s47, s24, 13
    s_add_u32 s47, s47, 0
    s_add_u32 m0, s54, s47
    s_add_u32 s47, s47, s51
    buffer_load_dwordx4 v29, s[16:19], s47 offen nt lds
    v_exp_f32 v84, v84
    v_exp_f32 v85, v85
    v_exp_f32 v86, v86
    s_waitcnt lgkmcnt(4)
    v_mfma_f32_32x32x16_bf16 v[64:79], a[8:11], v[40:43], v[64:79]
    ds_read_b128 a[0:3], v17 offset:8192
    ds_read_b128 a[4:7], v18 offset:8192
    buffer_load_dwordx4 v29, s[16:19], s47 offen offset:1024 nt lds
    v_exp_f32 v87, v87
    v_add_f32 v2, v2, v80
    v_add_f32 v9, v9, v81
    v_add_f32 v10, v10, v82
    v_add_f32 v11, v11, v83
    v_exp_f32 v88, v88
    v_mfma_f32_32x32x16_bf16 v[64:79], a[12:15], v[44:47], v[64:79]
    v_exp_f32 v89, v89
    v_exp_f32 v90, v90
    v_exp_f32 v91, v91
    s_waitcnt lgkmcnt(4)
    v_mfma_f32_32x32x16_bf16 v[64:79], a[16:19], v[48:51], v[64:79]
    ds_read_b128 a[8:11], v19 offset:8192
    ds_read_b128 a[12:15], v20 offset:8192
    buffer_load_dwordx4 v29, s[16:19], s47 offen offset:2048 nt lds
    v_add_f32 v2, v2, v84
    v_add_f32 v9, v9, v85
    v_add_f32 v10, v10, v86
    v_add_f32 v11, v11, v87
    v_cvt_pk_bf16_f32 v136, v80, v81
    v_cvt_pk_bf16_f32 v137, v82, v83
    v_cvt_pk_bf16_f32 v138, v84, v85
    v_mfma_f32_32x32x16_bf16 v[64:79], a[20:23], v[52:55], v[64:79]
    v_cvt_pk_bf16_f32 v139, v86, v87
    v_exp_f32 v92, v92
    v_exp_f32 v93, v93
    v_exp_f32 v94, v94
    s_waitcnt lgkmcnt(4)
    v_mfma_f32_32x32x16_bf16 v[64:79], a[24:27], v[56:59], v[64:79]
    ds_read_b128 a[16:19], v21 offset:8192
    ds_read_b128 a[20:23], v22 offset:8192
    buffer_load_dwordx4 v29, s[16:19], s47 offen offset:3072 nt lds
    v_exp_f32 v95, v95
    v_add_f32 v2, v2, v88
    v_add_f32 v9, v9, v89
    v_add_f32 v10, v10, v90
    v_add_f32 v11, v11, v91
    v_cvt_pk_bf16_f32 v140, v88, v89
    v_mfma_f32_32x32x16_bf16 v[64:79], a[28:31], v[60:63], v[64:79]
    v_cvt_pk_bf16_f32 v141, v90, v91
    v_add_f32 v2, v2, v92
    v_add_f32 v9, v9, v93
    v_add_f32 v10, v10, v94
    v_add_f32 v11, v11, v95
    v_cvt_pk_bf16_f32 v142, v92, v93
    v_cvt_pk_bf16_f32 v143, v94, v95
    s_waitcnt lgkmcnt(4)
    v_mfma_f32_32x32x16_bf16 v[80:95], a[0:3], v[32:35], v[176:191]
    ds_read_b128 a[24:27], v23 offset:8192
    ds_read_b128 a[28:31], v24 offset:8192
    v_exp_f32 v96, v96
    v_exp_f32 v97, v97
    v_exp_f32 v98, v98
    v_exp_f32 v99, v99
    v_mfma_f32_32x32x16_bf16 v[80:95], a[4:7], v[36:39], v[80:95]
    v_exp_f32 v100, v100
    v_exp_f32 v101, v101
    v_exp_f32 v102, v102
    s_waitcnt lgkmcnt(4)
    v_mfma_f32_32x32x16_bf16 v[80:95], a[8:11], v[40:43], v[80:95]
    ds_read_b128 a[0:3], v17 offset:16384
    ds_read_b128 a[4:7], v18 offset:16384
    v_exp_f32 v103, v103
    v_add_f32 v2, v2, v96
    v_add_f32 v9, v9, v97
    v_add_f32 v10, v10, v98
    v_add_f32 v11, v11, v99
    v_exp_f32 v104, v104
    v_mfma_f32_32x32x16_bf16 v[80:95], a[12:15], v[44:47], v[80:95]
    v_exp_f32 v105, v105
    v_exp_f32 v106, v106
    v_exp_f32 v107, v107
    s_waitcnt lgkmcnt(4)
    v_mfma_f32_32x32x16_bf16 v[80:95], a[16:19], v[48:51], v[80:95]
    ds_read_b128 a[8:11], v19 offset:16384
    ds_read_b128 a[12:15], v20 offset:16384
    v_add_f32 v2, v2, v100
    v_add_f32 v9, v9, v101
    v_add_f32 v10, v10, v102
    v_add_f32 v11, v11, v103
    v_cvt_pk_bf16_f32 v144, v96, v97
    v_cvt_pk_bf16_f32 v145, v98, v99
    v_cvt_pk_bf16_f32 v146, v100, v101
    v_mfma_f32_32x32x16_bf16 v[80:95], a[20:23], v[52:55], v[80:95]
    v_cvt_pk_bf16_f32 v147, v102, v103
    v_exp_f32 v108, v108
    v_exp_f32 v109, v109
    v_exp_f32 v110, v110
    s_waitcnt lgkmcnt(4)
    v_mfma_f32_32x32x16_bf16 v[80:95], a[24:27], v[56:59], v[80:95]
    ds_read_b128 a[16:19], v21 offset:16384
    ds_read_b128 a[20:23], v22 offset:16384
    v_exp_f32 v111, v111
    v_add_f32 v2, v2, v104
    v_add_f32 v9, v9, v105
    v_add_f32 v10, v10, v106
    v_add_f32 v11, v11, v107
    v_cvt_pk_bf16_f32 v148, v104, v105
    v_mfma_f32_32x32x16_bf16 v[80:95], a[28:31], v[60:63], v[80:95]
    v_cvt_pk_bf16_f32 v149, v106, v107
    v_add_f32 v2, v2, v108
    v_add_f32 v9, v9, v109
    v_add_f32 v10, v10, v110
    v_add_f32 v11, v11, v111
    v_cvt_pk_bf16_f32 v150, v108, v109
    v_cvt_pk_bf16_f32 v151, v110, v111
    s_waitcnt vmcnt(4)
    s_barrier
    s_waitcnt lgkmcnt(4)
    v_mfma_f32_32x32x16_bf16 v[96:111], a[0:3], v[32:35], v[176:191]
    ds_read_b128 a[24:27], v23 offset:16384
    ds_read_b128 a[28:31], v24 offset:16384
    v_exp_f32 v112, v112
    v_exp_f32 v113, v113
    v_exp_f32 v114, v114
    v_exp_f32 v115, v115
    v_mfma_f32_32x32x16_bf16 v[96:111], a[4:7], v[36:39], v[96:111]
    s_lshl_b32 s47, s24, 13
    s_add_u32 s47, s47, 4096
    s_add_u32 m0, s54, s47
    s_add_u32 s47, s47, s51
    buffer_load_dwordx4 v29, s[16:19], s47 offen nt lds
    v_exp_f32 v116, v116
    v_exp_f32 v117, v117
    v_exp_f32 v118, v118
    s_waitcnt lgkmcnt(4)
    v_mfma_f32_32x32x16_bf16 v[96:111], a[8:11], v[40:43], v[96:111]
    ds_read_b128 a[0:3], v17 offset:24576
    ds_read_b128 a[4:7], v18 offset:24576
    buffer_load_dwordx4 v29, s[16:19], s47 offen offset:1024 nt lds
    v_exp_f32 v119, v119
    v_add_f32 v2, v2, v112
    v_add_f32 v9, v9, v113
    v_add_f32 v10, v10, v114
    v_add_f32 v11, v11, v115
    v_exp_f32 v120, v120
    v_mfma_f32_32x32x16_bf16 v[96:111], a[12:15], v[44:47], v[96:111]
    buffer_load_dwordx4 v29, s[16:19], s47 offen offset:2048 nt lds
    v_exp_f32 v121, v121
    v_exp_f32 v122, v122
    v_exp_f32 v123, v123
    s_waitcnt lgkmcnt(4)
    v_mfma_f32_32x32x16_bf16 v[96:111], a[16:19], v[48:51], v[96:111]
    ds_read_b128 a[8:11], v19 offset:24576
    ds_read_b128 a[12:15], v20 offset:24576
    v_add_f32 v2, v2, v116
    v_add_f32 v9, v9, v117
    v_add_f32 v10, v10, v118
    v_add_f32 v11, v11, v119
    v_cvt_pk_bf16_f32 v152, v112, v113
    v_cvt_pk_bf16_f32 v153, v114, v115
    v_cvt_pk_bf16_f32 v154, v116, v117
    v_mfma_f32_32x32x16_bf16 v[96:111], a[20:23], v[52:55], v[96:111]
    buffer_load_dwordx4 v29, s[16:19], s47 offen offset:3072 nt lds
    v_cvt_pk_bf16_f32 v155, v118, v119
    v_exp_f32 v124, v124
    v_exp_f32 v125, v125
    v_exp_f32 v126, v126
    s_waitcnt lgkmcnt(4)
    v_mfma_f32_32x32x16_bf16 v[96:111], a[24:27], v[56:59], v[96:111]
    ds_read_b128 a[16:19], v21 offset:24576
    ds_read_b128 a[20:23], v22 offset:24576
    s_add_u32 s54, s54, 32768
    s_cmp_eq_u32 s54, 163840
    s_cselect_b32 s54, 0, s54
    s_add_u32 s51, s51, 32768
    v_exp_f32 v127, v127
    v_add_f32 v2, v2, v120
    v_add_f32 v9, v9, v121
    v_add_f32 v10, v10, v122
    v_add_f32 v11, v11, v123
    v_cvt_pk_bf16_f32 v156, v120, v121
    v_mfma_f32_32x32x16_bf16 v[96:111], a[28:31], v[60:63], v[96:111]
    v_cvt_pk_bf16_f32 v157, v122, v123
    v_add_f32 v2, v2, v124
    v_add_f32 v9, v9, v125
    v_add_f32 v10, v10, v126
    v_add_f32 v11, v11, v127
    v_cvt_pk_bf16_f32 v158, v124, v125
    v_cvt_pk_bf16_f32 v159, v126, v127
    s_waitcnt lgkmcnt(4)
    v_mfma_f32_32x32x16_bf16 v[112:127], a[0:3], v[32:35], v[176:191]
    ds_read_b128 a[24:27], v23 offset:24576
    ds_read_b128 a[28:31], v24 offset:24576
    v_mfma_f32_32x32x16_bf16 v[112:127], a[4:7], v[36:39], v[112:127]
    s_waitcnt lgkmcnt(4)
    v_mfma_f32_32x32x16_bf16 v[112:127], a[8:11], v[40:43], v[112:127]
    ds_read_b64_tr_b16 a[32:33], v13 offset:0
    ds_read_b64_tr_b16 a[34:35], v13 offset:1024
    v_mfma_f32_32x32x16_bf16 v[112:127], a[12:15], v[44:47], v[112:127]
    ds_read_b64_tr_b16 a[36:37], v14 offset:0
    ds_read_b64_tr_b16 a[38:39], v14 offset:1024
    s_waitcnt lgkmcnt(6)
    v_mfma_f32_32x32x16_bf16 v[112:127], a[16:19], v[48:51], v[112:127]
    ds_read_b64_tr_b16 a[40:41], v15 offset:0
    ds_read_b64_tr_b16 a[42:43], v15 offset:1024
    v_mfma_f32_32x32x16_bf16 v[112:127], a[20:23], v[52:55], v[112:127]
    ds_read_b64_tr_b16 a[44:45], v16 offset:0
    ds_read_b64_tr_b16 a[46:47], v16 offset:1024
    s_waitcnt lgkmcnt(8)
    v_mfma_f32_32x32x16_bf16 v[112:127], a[24:27], v[56:59], v[112:127]
    v_mfma_f32_32x32x16_bf16 v[112:127], a[28:31], v[60:63], v[112:127]
    s_waitcnt lgkmcnt(4)
    v_mfma_f32_32x32x16_bf16 v[192:207], a[32:35], v[128:131], v[192:207]
    ds_read_b64_tr_b16 a[48:49], v13 offset:4096
    ds_read_b64_tr_b16 a[50:51], v13 offset:5120
    v_max3_f32 v5, v64, v65, v66
    v_max3_f32 v5, v5, v67, v68
    v_max3_f32 v5, v5, v69, v70
    v_max3_f32 v5, v5, v71, v72
    v_mfma_f32_32x32x16_bf16 v[208:223], a[36:39], v[128:131], v[208:223]
    ds_read_b64_tr_b16 a[52:53], v14 offset:4096
    ds_read_b64_tr_b16 a[54:55], v14 offset:5120
    v_max3_f32 v5, v5, v73, v74
    v_max3_f32 v5, v5, v75, v76
    v_max3_f32 v5, v5, v77, v78
    v_max_f32 v5, v5, v79
    v_max3_f32 v6, v80, v81, v82
    s_waitcnt lgkmcnt(4)
    v_mfma_f32_32x32x16_bf16 v[224:239], a[40:43], v[128:131], v[224:239]
    ds_read_b64_tr_b16 a[56:57], v15 offset:4096
    ds_read_b64_tr_b16 a[58:59], v15 offset:5120
    v_max3_f32 v6, v6, v83, v84
    v_max3_f32 v6, v6, v85, v86
    v_max3_f32 v6, v6, v87, v88
    v_max3_f32 v6, v6, v89, v90
    v_mfma_f32_32x32x16_bf16 v[240:255], a[44:47], v[128:131], v[240:255]
    ds_read_b64_tr_b16 a[60:61], v16 offset:4096
    ds_read_b64_tr_b16 a[62:63], v16 offset:5120
    v_max3_f32 v6, v6, v91, v92
    v_max3_f32 v6, v6, v93, v94
    v_max_f32 v6, v6, v95
    v_max3_f32 v7, v96, v97, v98
    v_max3_f32 v7, v7, v99, v100
    s_waitcnt lgkmcnt(4)
    v_mfma_f32_32x32x16_bf16 v[192:207], a[48:51], v[132:135], v[192:207]
    ds_read_b64_tr_b16 a[32:33], v13 offset:8192
    ds_read_b64_tr_b16 a[34:35], v13 offset:9216
    v_max3_f32 v7, v7, v101, v102
    v_max3_f32 v7, v7, v103, v104
    v_max3_f32 v7, v7, v105, v106
    v_max3_f32 v7, v7, v107, v108
    v_mfma_f32_32x32x16_bf16 v[208:223], a[52:55], v[132:135], v[208:223]
    ds_read_b64_tr_b16 a[36:37], v14 offset:8192
    ds_read_b64_tr_b16 a[38:39], v14 offset:9216
    v_max3_f32 v7, v7, v109, v110
    v_max_f32 v7, v7, v111
    v_max3_f32 v8, v112, v113, v114
    v_max3_f32 v8, v8, v115, v116
    s_waitcnt lgkmcnt(4)
    v_mfma_f32_32x32x16_bf16 v[224:239], a[56:59], v[132:135], v[224:239]
    ds_read_b64_tr_b16 a[40:41], v15 offset:8192
    ds_read_b64_tr_b16 a[42:43], v15 offset:9216
    v_max3_f32 v8, v8, v117, v118
    v_max3_f32 v8, v8, v119, v120
    v_max3_f32 v8, v8, v121, v122
    v_max3_f32 v8, v8, v123, v124
    v_max3_f32 v8, v8, v125, v126
    v_mfma_f32_32x32x16_bf16 v[240:255], a[60:63], v[132:135], v[240:255]
    ds_read_b64_tr_b16 a[44:45], v16 offset:8192
    ds_read_b64_tr_b16 a[46:47], v16 offset:9216
    v_max_f32 v8, v8, v127
    v_max3_f32 v5, v5, v6, v7
    v_max_f32 v5, v5, v8
    v_cmp_lt_f32 vcc, s52, v5
    s_waitcnt lgkmcnt(4)
    v_mfma_f32_32x32x16_bf16 v[192:207], a[32:35], v[136:139], v[192:207]
    ds_read_b64_tr_b16 a[48:49], v13 offset:12288
    ds_read_b64_tr_b16 a[50:51], v13 offset:13312
    v_mfma_f32_32x32x16_bf16 v[208:223], a[36:39], v[136:139], v[208:223]
    ds_read_b64_tr_b16 a[52:53], v14 offset:12288
    ds_read_b64_tr_b16 a[54:55], v14 offset:13312
    s_cbranch_vccnz L_raise3
L_raise3_back:
    s_waitcnt lgkmcnt(4)
    v_mfma_f32_32x32x16_bf16 v[224:239], a[40:43], v[136:139], v[224:239]
    ds_read_b64_tr_b16 a[56:57], v15 offset:12288
    ds_read_b64_tr_b16 a[58:59], v15 offset:13312
    v_exp_f32 v64, v64
    v_exp_f32 v65, v65
    v_mfma_f32_32x32x16_bf16 v[240:255], a[44:47], v[136:139], v[240:255]
    ds_read_b64_tr_b16 a[60:61], v16 offset:12288
    ds_read_b64_tr_b16 a[62:63], v16 offset:13312
    v_exp_f32 v66, v66
    v_exp_f32 v67, v67
    s_waitcnt lgkmcnt(4)
    v_mfma_f32_32x32x16_bf16 v[192:207], a[48:51], v[140:143], v[192:207]
    ds_read_b64_tr_b16 a[32:33], v13 offset:16384
    ds_read_b64_tr_b16 a[34:35], v13 offset:17408
    v_exp_f32 v68, v68
    v_exp_f32 v69, v69
    v_mfma_f32_32x32x16_bf16 v[208:223], a[52:55], v[140:143], v[208:223]
    ds_read_b64_tr_b16 a[36:37], v14 offset:16384
    ds_read_b64_tr_b16 a[38:39], v14 offset:17408
    v_exp_f32 v70, v70
    s_waitcnt lgkmcnt(4)
    v_mfma_f32_32x32x16_bf16 v[224:239], a[56:59], v[140:143], v[224:239]
    ds_read_b64_tr_b16 a[40:41], v15 offset:16384
    ds_read_b64_tr_b16 a[42:43], v15 offset:17408
    v_exp_f32 v71, v71
    v_add_f32 v2, v2, v64
    v_mfma_f32_32x32x16_bf16 v[240:255], a[60:63], v[140:143], v[240:255]
    ds_read_b64_tr_b16 a[44:45], v16 offset:16384
    ds_read_b64_tr_b16 a[46:47], v16 offset:17408
    v_add_f32 v9, v9, v65
    v_add_f32 v10, v10, v66
    v_add_f32 v11, v11, v67
    s_waitcnt lgkmcnt(4)
    v_mfma_f32_32x32x16_bf16 v[192:207], a[32:35], v[144:147], v[192:207]
    ds_read_b64_tr_b16 a[48:49], v13 offset:20480
    ds_read_b64_tr_b16 a[50:51], v13 offset:21504
    v_exp_f32 v72, v72
    v_exp_f32 v73, v73
    v_mfma_f32_32x32x16_bf16 v[208:223], a[36:39], v[144:147], v[208:223]
    ds_read_b64_tr_b16 a[52:53], v14 offset:20480
    ds_read_b64_tr_b16 a[54:55], v14 offset:21504
    v_exp_f32 v74, v74
    v_exp_f32 v75, v75
    v_add_f32 v2, v2, v68
    s_waitcnt lgkmcnt(4)
    v_mfma_f32_32x32x16_bf16 v[224:239], a[40:43], v[144:147], v[224:239]
    ds_read_b64_tr_b16 a[56:57], v15 offset:20480
    ds_read_b64_tr_b16 a[58:59], v15 offset:21504
    v_add_f32 v9, v9, v69
    v_add_f32 v10, v10, v70
    v_add_f32 v11, v11, v71
    v_cvt_pk_bf16_f32 v128, v64, v65
    v_cvt_pk_bf16_f32 v129, v66, v67
    v_mfma_f32_32x32x16_bf16 v[240:255], a[44:47], v[144:147], v[240:255]
    ds_read_b64_tr_b16 a[60:61], v16 offset:20480
    ds_read_b64_tr_b16 a[62:63], v16 offset:21504
    v_cvt_pk_bf16_f32 v130, v68, v69
    v_cvt_pk_bf16_f32 v131, v70, v71
    v_exp_f32 v76, v76
    s_waitcnt lgkmcnt(4)
    v_mfma_f32_32x32x16_bf16 v[192:207], a[48:51], v[148:151], v[192:207]
    ds_read_b64_tr_b16 a[32:33], v13 offset:24576
    ds_read_b64_tr_b16 a[34:35], v13 offset:25600
    v_exp_f32 v77, v77
    v_exp_f32 v78, v78
    v_mfma_f32_32x32x16_bf16 v[208:223], a[52:55], v[148:151], v[208:223]
    ds_read_b64_tr_b16 a[36:37], v14 offset:24576
    ds_read_b64_tr_b16 a[38:39], v14 offset:25600
    v_exp_f32 v79, v79
    v_add_f32 v2, v2, v72
    v_add_f32 v9, v9, v73
    v_add_f32 v10, v10, v74
    s_waitcnt lgkmcnt(4)
    v_mfma_f32_32x32x16_bf16 v[224:239], a[56:59], v[148:151], v[224:239]
    ds_read_b64_tr_b16 a[40:41], v15 offset:24576
    ds_read_b64_tr_b16 a[42:43], v15 offset:25600
    v_add_f32 v11, v11, v75
    v_cvt_pk_bf16_f32 v132, v72, v73
    v_cvt_pk_bf16_f32 v133, v74, v75
    v_add_f32 v2, v2, v76
    v_add_f32 v9, v9, v77
    v_mfma_f32_32x32x16_bf16 v[240:255], a[60:63], v[148:151], v[240:255]
    ds_read_b64_tr_b16 a[44:45], v16 offset:24576
    ds_read_b64_tr_b16 a[46:47], v16 offset:25600
    v_add_f32 v10, v10, v78
    v_add_f32 v11, v11, v79
    v_cvt_pk_bf16_f32 v134, v76, v77
    v_cvt_pk_bf16_f32 v135, v78, v79
    s_waitcnt lgkmcnt(4)
    v_mfma_f32_32x32x16_bf16 v[192:207], a[32:35], v[152:155], v[192:207]
    ds_read_b64_tr_b16 a[48:49], v13 offset:28672
    ds_read_b64_tr_b16 a[50:51], v13 offset:29696
    v_mfma_f32_32x32x16_bf16 v[208:223], a[36:39], v[152:155], v[208:223]
    ds_read_b64_tr_b16 a[52:53], v14 offset:28672
    ds_read_b64_tr_b16 a[54:55], v14 offset:29696
    s_waitcnt lgkmcnt(4)
    v_mfma_f32_32x32x16_bf16 v[224:239], a[40:43], v[152:155], v[224:239]
    ds_read_b64_tr_b16 a[56:57], v15 offset:28672
    ds_read_b64_tr_b16 a[58:59], v15 offset:29696
    v_mfma_f32_32x32x16_bf16 v[240:255], a[44:47], v[152:155], v[240:255]
    ds_read_b64_tr_b16 a[60:61], v16 offset:28672
    ds_read_b64_tr_b16 a[62:63], v16 offset:29696
    s_waitcnt lgkmcnt(4)
    v_mfma_f32_32x32x16_bf16 v[192:207], a[48:51], v[156:159], v[192:207]
    v_mfma_f32_32x32x16_bf16 v[208:223], a[52:55], v[156:159], v[208:223]
    s_waitcnt lgkmcnt(0)
    v_mfma_f32_32x32x16_bf16 v[224:239], a[56:59], v[156:159], v[224:239]
    v_mfma_f32_32x32x16_bf16 v[240:255], a[60:63], v[156:159], v[240:255]
    v_add_u32 v13, 4294836224, v13
    v_add_u32 v14, 4294836224, v14
    v_add_u32 v15, 4294836224, v15
    v_add_u32 v16, 4294836224, v16
L_p2:
    s_lshr_b32 s60, s58, 1
    s_xor_b32 s59, s60, 1
    s_lshl_b32 s46, s58, 21
    s_lshl_b32 s47, s57, 8
    s_add_u32 s46, s46, s47
    s_add_u32 s8, s88, s46
    s_addc_u32 s9, s89, 0
    s_and_b32 s9, s9, 0xffff
    s_mov_b32 s10, 0
    s_mov_b32 s11, 0x20000
    s_sub_u32 s10, 8388608, s46
    s_lshl_b32 s46, s25, 2
    s_add_u32 s46, s46, s24
    s_lshl_b32 s46, s46, 8
    s_lshl_b32 s47, s58, 6
    s_add_u32 s46, s46, s47
    s_lshl_b32 s46, s46, 10
    s_add_u32 s46, s46, 0
    s_add_u32 s4, s94, s46
    s_addc_u32 s5, s95, 0
    s_and_b32 s5, s5, 0xffff
    s_mov_b32 s6, 65536
    s_mov_b32 s7, 0x20000
    s_lshl_b32 s46, s25, 3
    s_add_u32 s46, s46, s57
    s_lshl_b32 s61, s46, 7
    s_lshl_b32 s46, s46, 6
    s_add_u32 s46, s46, s24
    s_lshl_b32 s46, s46, 12
    s_add_u32 s46, s46, 16777216
    s_add_u32 s12, s94, s46
    s_addc_u32 s13, s95, 0
    s_and_b32 s13, s13, 0xffff
    s_mov_b32 s14, 249856
    s_mov_b32 s15, 0x20000
    s_add_u32 s61, s61, 50339840
    s_lshl_b32 s62, s25, 2
    s_add_u32 s62, s62, s58
    s_lshl_b32 s62, s62, 7
    s_add_u32 s62, s62, 50331648
    s_mov_b32 s16, s90
    s_and_b32 s17, s91, 0xffff
    s_mov_b32 s18, 2097152
    s_mov_b32 s19, 0x20000
    v_lshrrev_b32 v5, 3, v30
    v_mov_b32 v6, s24
    v_lshl_add_u32 v5, v6, 5, v5
    v_lshlrev_b32 v5, 11, v5
    v_bfe_u32 v6, v30, 4, 1
    v_lshlrev_b32 v6, 2, v6
    v_and_b32 v7, 7, v30
    v_xor_b32 v6, v6, v7
    v_lshl_add_u32 v162, v6, 4, v5
    v_add_u32 v163, 15360, v162
    v_add_u32 v164, 30720, v162
    v_add_u32 v165, 46080, v162
    s_mov_b32 s63, 0
    v_mov_b32 v5, 0
    global_load_dwordx2 v[160:161], v5, s[92:93] sc1
    s_cmp_lg_u32 s98, 0
    s_cbranch_scc1 L_rs_a3
L_rs_a3_back:
    v_exp_f32 v80, v80
    v_exp_f32 v81, v81
    v_exp_f32 v82, v82
    v_exp_f32 v83, v83
    v_exp_f32 v84, v84
    v_exp_f32 v85, v85
    v_exp_f32 v86, v86
    v_exp_f32 v87, v87
    v_add_f32 v2, v2, v80
    v_add_f32 v9, v9, v81
    v_add_f32 v10, v10, v82
    s_add_u32 s34, s56, 0
    s_and_b32 s34, s34, 3
    s_add_u32 s33, s34, s57
    s_and_b32 s33, s33, 7
    s_lshl_b32 s34, s34, 14
    s_add_u32 s34, s34, s31
    s_add_u32 m0, s34, 32768
    s_lshl_b32 s33, s33, 18
    s_lshl_b32 s34, s59, 7
    s_add_u32 s33, s33, s34
    buffer_load_dwordx4 v162, s[8:11], s33 offen  lds
    v_add_f32 v11, v11, v83
    v_exp_f32 v88, v88
    v_exp_f32 v89, v89
    v_exp_f32 v90, v90
    v_exp_f32 v91, v91
    v_add_f32 v2, v2, v84
    v_add_f32 v9, v9, v85
    v_add_f32 v10, v10, v86
    v_add_f32 v11, v11, v87
    v_cvt_pk_bf16_f32 v136, v80, v81
    v_cvt_pk_bf16_f32 v137, v82, v83
    v_cvt_pk_bf16_f32 v138, v84, v85
    buffer_load_dwordx4 v163, s[8:11], s33 offen offset:1024  lds
    v_cvt_pk_bf16_f32 v139, v86, v87
    v_exp_f32 v92, v92
    v_exp_f32 v93, v93
    v_exp_f32 v94, v94
    v_exp_f32 v95, v95
    v_add_f32 v2, v2, v88
    v_add_f32 v9, v9, v89
    v_add_f32 v10, v10, v90
    v_add_f32 v11, v11, v91
    v_cvt_pk_bf16_f32 v140, v88, v89
    v_cvt_pk_bf16_f32 v141, v90, v91
    v_add_f32 v2, v2, v92
    v_add_f32 v9, v9, v93
    buffer_load_dwordx4 v164, s[8:11], s33 offen offset:2048  lds
    v_add_f32 v10, v10, v94
    v_add_f32 v11, v11, v95
    v_cvt_pk_bf16_f32 v142, v92, v93
    v_cvt_pk_bf16_f32 v143, v94, v95
    v_exp_f32 v96, v96
    v_exp_f32 v97, v97
    v_exp_f32 v98, v98
    v_exp_f32 v99, v99
    v_exp_f32 v100, v100
    v_exp_f32 v101, v101
    v_exp_f32 v102, v102
    v_exp_f32 v103, v103
    buffer_load_dwordx4 v165, s[8:11], s33 offen offset:3072  lds
    v_add_f32 v2, v2, v96
    v_add_f32 v9, v9, v97
    v_add_f32 v10, v10, v98
    v_add_f32 v11, v11, v99
    v_exp_f32 v104, v104
    v_exp_f32 v105, v105
    v_exp_f32 v106, v106
    v_exp_f32 v107, v107
    v_add_f32 v2, v2, v100
    v_add_f32 v9, v9, v101
    v_add_f32 v10, v10, v102
    v_add_f32 v11, v11, v103
    v_cvt_pk_bf16_f32 v144, v96, v97
    s_add_u32 s34, s56, 1
    s_and_b32 s34, s34, 3
    s_add_u32 s33, s34, s57
    s_and_b32 s33, s33, 7
    s_lshl_b32 s34, s34, 14
    s_add_u32 s34, s34, s31
    s_add_u32 m0, s34, 32768
    s_lshl_b32 s33, s33, 18
    s_lshl_b32 s34, s59, 7
    s_add_u32 s33, s33, s34
    buffer_load_dwordx4 v162, s[8:11], s33 offen  lds
    v_cvt_pk_bf16_f32 v145, v98, v99
    v_cvt_pk_bf16_f32 v146, v100, v101
    v_cvt_pk_bf16_f32 v147, v102, v103
    v_exp_f32 v108, v108
    v_exp_f32 v109, v109
    v_exp_f32 v110, v110
    v_exp_f32 v111, v111
    v_add_f32 v2, v2, v104
    v_add_f32 v9, v9, v105
    v_add_f32 v10, v10, v106
    v_add_f32 v11, v11, v107
    v_cvt_pk_bf16_f32 v148, v104, v105
    buffer_load_dwordx4 v163, s[8:11], s33 offen offset:1024  lds
    v_cvt_pk_bf16_f32 v149, v106, v107
    v_add_f32 v2, v2, v108
    v_add_f32 v9, v9, v109
    v_add_f32 v10, v10, v110
    v_add_f32 v11, v11, v111
    v_cvt_pk_bf16_f32 v150, v108, v109
    v_cvt_pk_bf16_f32 v151, v110, v111
    v_exp_f32 v112, v112
    v_exp_f32 v113, v113
    v_exp_f32 v114, v114
    v_exp_f32 v115, v115
    v_exp_f32 v116, v116
    v_exp_f32 v117, v117
    buffer_load_dwordx4 v164, s[8:11], s33 offen offset:2048  lds
    v_exp_f32 v118, v118
    v_exp_f32 v119, v119
    v_add_f32 v2, v2, v112
    v_add_f32 v9, v9, v113
    v_add_f32 v10, v10, v114
    v_add_f32 v11, v11, v115
    v_exp_f32 v120, v120
    v_exp_f32 v121, v121
    v_exp_f32 v122, v122
    v_exp_f32 v123, v123
    v_add_f32 v2, v2, v116
    v_add_f32 v9, v9, v117
    buffer_load_dwordx4 v165, s[8:11], s33 offen offset:3072  lds
    v_add_f32 v10, v10, v118
    v_add_f32 v11, v11, v119
    v_cvt_pk_bf16_f32 v152, v112, v113
    v_cvt_pk_bf16_f32 v153, v114, v115
    v_cvt_pk_bf16_f32 v154, v116, v117
    v_cvt_pk_bf16_f32 v155, v118, v119
    v_exp_f32 v124, v124
    v_exp_f32 v125, v125
    v_exp_f32 v126, v126
    v_exp_f32 v127, v127
    v_add_f32 v2, v2, v120
    v_add_f32 v9, v9, v121
    v_add_f32 v10, v10, v122
    v_add_f32 v11, v11, v123
    v_cvt_pk_bf16_f32 v156, v120, v121
    v_cvt_pk_bf16_f32 v157, v122, v123
    v_add_f32 v2, v2, v124
    v_add_f32 v9, v9, v125
    v_add_f32 v10, v10, v126
    v_add_f32 v11, v11, v127
    v_cvt_pk_bf16_f32 v158, v124, v125
    v_cvt_pk_bf16_f32 v159, v126, v127
    v_add_f32 v9, v9, v10
    v_add_f32 v2, v2, v11
    v_add_f32 v2, v2, v9
    v_mov_b32 v5, v2
    v_lshlrev_b32 v17, 4, v30
    v_add_u32 v18, 4096, v17
    v_permlane32_swap_b32 v2, v5
    v_add_f32 v2, v2, v5
    v_rcp_f32 v2, v2
    s_waitcnt vmcnt(8)
    s_barrier
    ds_read_b64_tr_b16 a[32:33], v13 offset:0
    ds_read_b64_tr_b16 a[34:35], v13 offset:1024
    ds_read_b64_tr_b16 a[36:37], v13 offset:4096
    ds_read_b64_tr_b16 a[38:39], v13 offset:5120
    ds_read_b64_tr_b16 a[40:41], v13 offset:8192
    ds_read_b64_tr_b16 a[42:43], v13 offset:9216
    ds_read_b64_tr_b16 a[44:45], v13 offset:12288
    ds_read_b64_tr_b16 a[46:47], v13 offset:13312
    ds_read_b64_tr_b16 a[48:49], v13 offset:16384
    ds_read_b64_tr_b16 a[50:51], v13 offset:17408
    ds_read_b64_tr_b16 a[52:53], v13 offset:20480
    ds_read_b64_tr_b16 a[54:55], v13 offset:21504
    s_waitcnt lgkmcnt(8)
    v_mfma_f32_32x32x16_bf16 v[192:207], a[32:35], v[128:131], v[192:207]
    ds_read_b64_tr_b16 a[56:57], v13 offset:24576
    ds_read_b64_tr_b16 a[58:59], v13 offset:25600
    ds_read_b64_tr_b16 a[60:61], v13 offset:28672
    ds_read_b64_tr_b16 a[62:63], v13 offset:29696
    s_add_u32 s34, s56, 2
    s_and_b32 s34, s34, 3
    s_add_u32 s33, s34, s57
    s_and_b32 s33, s33, 7
    s_lshl_b32 s34, s34, 14
    s_add_u32 s34, s34, s31
    s_add_u32 m0, s34, 32768
    s_lshl_b32 s33, s33, 18
    s_lshl_b32 s34, s59, 7
    s_add_u32 s33, s33, s34
    buffer_load_dwordx4 v162, s[8:11], s33 offen  lds
    v_mfma_f32_32x32x16_bf16 v[192:207], a[36:39], v[132:135], v[192:207]
    buffer_load_dwordx4 v163, s[8:11], s33 offen offset:1024  lds
    s_waitcnt lgkmcnt(8)
    v_mfma_f32_32x32x16_bf16 v[192:207], a[40:43], v[136:139], v[192:207]
    ds_read_b64_tr_b16 a[32:33], v14 offset:0
    ds_read_b64_tr_b16 a[34:35], v14 offset:1024
    ds_read_b64_tr_b16 a[36:37], v14 offset:4096
    ds_read_b64_tr_b16 a[38:39], v14 offset:5120
    buffer_load_dwordx4 v164, s[8:11], s33 offen offset:2048  lds
    v_mfma_f32_32x32x16_bf16 v[192:207], a[44:47], v[140:143], v[192:207]
    buffer_load_dwordx4 v165, s[8:11], s33 offen offset:3072  lds
    s_waitcnt lgkmcnt(8)
    v_mfma_f32_32x32x16_bf16 v[192:207], a[48:51], v[144:147], v[192:207]
    ds_read_b64_tr_b16 a[40:41], v14 offset:8192
    ds_read_b64_tr_b16 a[42:43], v14 offset:9216
    ds_read_b64_tr_b16 a[44:45], v14 offset:12288
    ds_read_b64_tr_b16 a[46:47], v14 offset:13312
    s_add_u32 s34, s56, 3
    s_and_b32 s34, s34, 3
    s_add_u32 s33, s34, s57
    s_and_b32 s33, s33, 7
    s_lshl_b32 s34, s34, 14
    s_add_u32 s34, s34, s31
    s_add_u32 m0, s34, 32768
    s_lshl_b32 s33, s33, 18
    s_lshl_b32 s34, s59, 7
    s_add_u32 s33, s33, s34
    buffer_load_dwordx4 v162, s[8:11], s33 offen  lds
    v_mfma_f32_32x32x16_bf16 v[192:207], a[52:55], v[148:151], v[192:207]
    buffer_load_dwordx4 v163, s[8:11], s33 offen offset:1024  lds
    s_waitcnt lgkmcnt(8)
    v_mfma_f32_32x32x16_bf16 v[192:207], a[56:59], v[152:155], v[192:207]
    ds_read_b64_tr_b16 a[48:49], v14 offset:16384
    ds_read_b64_tr_b16 a[50:51], v14 offset:17408
    ds_read_b64_tr_b16 a[52:53], v14 offset:20480
    ds_read_b64_tr_b16 a[54:55], v14 offset:21504
    buffer_load_dwordx4 v164, s[8:11], s33 offen offset:2048  lds
    v_mfma_f32_32x32x16_bf16 v[192:207], a[60:63], v[156:159], v[192:207]
    buffer_load_dwordx4 v165, s[8:11], s33 offen offset:3072  lds
    s_waitcnt lgkmcnt(8)
    v_mfma_f32_32x32x16_bf16 v[208:223], a[32:35], v[128:131], v[208:223]
    ds_read_b64_tr_b16 a[56:57], v14 offset:24576
    ds_read_b64_tr_b16 a[58:59], v14 offset:25600
    ds_read_b64_tr_b16 a[60:61], v14 offset:28672
    ds_read_b64_tr_b16 a[62:63], v14 offset:29696
    v_mfma_f32_32x32x16_bf16 v[208:223], a[36:39], v[132:135], v[208:223]
    s_waitcnt lgkmcnt(8)
    v_mfma_f32_32x32x16_bf16 v[208:223], a[40:43], v[136:139], v[208:223]
    ds_read_b64_tr_b16 a[32:33], v15 offset:0
    ds_read_b64_tr_b16 a[34:35], v15 offset:1024
    ds_read_b64_tr_b16 a[36:37], v15 offset:4096
    ds_read_b64_tr_b16 a[38:39], v15 offset:5120
    v_mfma_f32_32x32x16_bf16 v[208:223], a[44:47], v[140:143], v[208:223]
    v_mul_f32 v192, v192, v2
    v_mul_f32 v193, v193, v2
    v_mul_f32 v194, v194, v2
    v_mul_f32 v195, v195, v2
    v_mul_f32 v196, v196, v2
    v_mul_f32 v197, v197, v2
    s_waitcnt lgkmcnt(8)
    v_mfma_f32_32x32x16_bf16 v[208:223], a[48:51], v[144:147], v[208:223]
    ds_read_b64_tr_b16 a[40:41], v15 offset:8192
    ds_read_b64_tr_b16 a[42:43], v15 offset:9216
    ds_read_b64_tr_b16 a[44:45], v15 offset:12288
    ds_read_b64_tr_b16 a[46:47], v15 offset:13312
    v_mul_f32 v198, v198, v2
    v_mul_f32 v199, v199, v2
    v_cvt_pk_bf16_f32 v64, v192, v193
    v_cvt_pk_bf16_f32 v65, v194, v195
    v_cvt_pk_bf16_f32 v66, v196, v197
    v_cvt_pk_bf16_f32 v67, v198, v199
    buffer_store_dwordx4 v[64:67], v17, s[20:23], 0 offen offset:0 sc1
    v_mfma_f32_32x32x16_bf16 v[208:223], a[52:55], v[148:151], v[208:223]
    v_accvgpr_write_b32 a0, v64
    v_accvgpr_write_b32 a1, v65
    v_accvgpr_write_b32 a2, v66
    v_accvgpr_write_b32 a3, v67
    v_mul_f32 v200, v200, v2
    v_mul_f32 v201, v201, v2
    v_mul_f32 v202, v202, v2
    s_waitcnt lgkmcnt(8)
    v_mfma_f32_32x32x16_bf16 v[208:223], a[56:59], v[152:155], v[208:223]
    ds_read_b64_tr_b16 a[48:49], v15 offset:16384
    ds_read_b64_tr_b16 a[50:51], v15 offset:17408
    ds_read_b64_tr_b16 a[52:53], v15 offset:20480
    ds_read_b64_tr_b16 a[54:55], v15 offset:21504
    v_mul_f32 v203, v203, v2
    v_mul_f32 v204, v204, v2
    v_mul_f32 v205, v205, v2
    v_mul_f32 v206, v206, v2
    v_mul_f32 v207, v207, v2
    v_cvt_pk_bf16_f32 v68, v200, v201
    v_cvt_pk_bf16_f32 v69, v202, v203
    v_mfma_f32_32x32x16_bf16 v[208:223], a[60:63], v[156:159], v[208:223]
    v_cvt_pk_bf16_f32 v70, v204, v205
    v_cvt_pk_bf16_f32 v71, v206, v207
    buffer_store_dwordx4 v[68:71], v17, s[20:23], 0 offen offset:1024 sc1
    v_accvgpr_write_b32 a4, v68
    v_accvgpr_write_b32 a5, v69
    v_accvgpr_write_b32 a6, v70
    v_accvgpr_write_b32 a7, v71
    s_waitcnt lgkmcnt(8)
    v_mfma_f32_32x32x16_bf16 v[224:239], a[32:35], v[128:131], v[224:239]
    ds_read_b64_tr_b16 a[56:57], v15 offset:24576
    ds_read_b64_tr_b16 a[58:59], v15 offset:25600
    ds_read_b64_tr_b16 a[60:61], v15 offset:28672
    ds_read_b64_tr_b16 a[62:63], v15 offset:29696
    v_mfma_f32_32x32x16_bf16 v[224:239], a[36:39], v[132:135], v[224:239]
    s_waitcnt lgkmcnt(8)
    v_mfma_f32_32x32x16_bf16 v[224:239], a[40:43], v[136:139], v[224:239]
    ds_read_b64_tr_b16 a[32:33], v16 offset:0
    ds_read_b64_tr_b16 a[34:35], v16 offset:1024
    ds_read_b64_tr_b16 a[36:37], v16 offset:4096
    ds_read_b64_tr_b16 a[38:39], v16 offset:5120
    v_mfma_f32_32x32x16_bf16 v[224:239], a[44:47], v[140:143], v[224:239]
    v_mul_f32 v208, v208, v2
    v_mul_f32 v209, v209, v2
    v_mul_f32 v210, v210, v2
    v_mul_f32 v211, v211, v2
    v_mul_f32 v212, v212, v2
    v_mul_f32 v213, v213, v2
    s_waitcnt lgkmcnt(8)
    v_mfma_f32_32x32x16_bf16 v[224:239], a[48:51], v[144:147], v[224:239]
    ds_read_b64_tr_b16 a[40:41], v16 offset:8192
    ds_read_b64_tr_b16 a[42:43], v16 offset:9216
    ds_read_b64_tr_b16 a[44:45], v16 offset:12288
    ds_read_b64_tr_b16 a[46:47], v16 offset:13312
    v_mul_f32 v214, v214, v2
    v_mul_f32 v215, v215, v2
    v_cvt_pk_bf16_f32 v72, v208, v209
    v_cvt_pk_bf16_f32 v73, v210, v211
    v_cvt_pk_bf16_f32 v74, v212, v213
    v_cvt_pk_bf16_f32 v75, v214, v215
    buffer_store_dwordx4 v[72:75], v17, s[20:23], 0 offen offset:2048 sc1
    v_mfma_f32_32x32x16_bf16 v[224:239], a[52:55], v[148:151], v[224:239]
    v_accvgpr_write_b32 a8, v72
    v_accvgpr_write_b32 a9, v73
    v_accvgpr_write_b32 a10, v74
    v_accvgpr_write_b32 a11, v75
    v_mul_f32 v216, v216, v2
    v_mul_f32 v217, v217, v2
    v_mul_f32 v218, v218, v2
    s_waitcnt lgkmcnt(8)
    v_mfma_f32_32x32x16_bf16 v[224:239], a[56:59], v[152:155], v[224:239]
    ds_read_b64_tr_b16 a[48:49], v16 offset:16384
    ds_read_b64_tr_b16 a[50:51], v16 offset:17408
    ds_read_b64_tr_b16 a[52:53], v16 offset:20480
    ds_read_b64_tr_b16 a[54:55], v16 offset:21504
    v_mul_f32 v219, v219, v2
    v_mul_f32 v220, v220, v2
    v_mul_f32 v221, v221, v2
    v_mul_f32 v222, v222, v2
    v_mul_f32 v223, v223, v2
    v_cvt_pk_bf16_f32 v76, v216, v217
    v_cvt_pk_bf16_f32 v77, v218, v219
    v_mfma_f32_32x32x16_bf16 v[224:239], a[60:63], v[156:159], v[224:239]
    v_cvt_pk_bf16_f32 v78, v220, v221
    v_cvt_pk_bf16_f32 v79, v222, v223
    buffer_store_dwordx4 v[76:79], v17, s[20:23], 0 offen offset:3072 sc1
    v_accvgpr_write_b32 a12, v76
    v_accvgpr_write_b32 a13, v77
    v_accvgpr_write_b32 a14, v78
    v_accvgpr_write_b32 a15, v79
    s_waitcnt lgkmcnt(8)
    v_mfma_f32_32x32x16_bf16 v[240:255], a[32:35], v[128:131], v[240:255]
    ds_read_b64_tr_b16 a[56:57], v16 offset:24576
    ds_read_b64_tr_b16 a[58:59], v16 offset:25600
    ds_read_b64_tr_b16 a[60:61], v16 offset:28672
    ds_read_b64_tr_b16 a[62:63], v16 offset:29696
    v_mfma_f32_32x32x16_bf16 v[240:255], a[36:39], v[132:135], v[240:255]
    s_waitcnt lgkmcnt(8)
    v_mfma_f32_32x32x16_bf16 v[240:255], a[40:43], v[136:139], v[240:255]
    v_mfma_f32_32x32x16_bf16 v[240:255], a[44:47], v[140:143], v[240:255]
    v_mul_f32 v224, v224, v2
    v_mul_f32 v225, v225, v2
    v_mul_f32 v226, v226, v2
    v_mul_f32 v227, v227, v2
    v_mul_f32 v228, v228, v2
    v_mul_f32 v229, v229, v2
    s_waitcnt lgkmcnt(4)
    v_mfma_f32_32x32x16_bf16 v[240:255], a[48:51], v[144:147], v[240:255]
    v_mul_f32 v230, v230, v2
    v_mul_f32 v231, v231, v2
    v_cvt_pk_bf16_f32 v80, v224, v225
    v_cvt_pk_bf16_f32 v81, v226, v227
    v_cvt_pk_bf16_f32 v82, v228, v229
    v_cvt_pk_bf16_f32 v83, v230, v231
    buffer_store_dwordx4 v[80:83], v18, s[20:23], 0 offen offset:0 sc1
    v_mfma_f32_32x32x16_bf16 v[240:255], a[52:55], v[148:151], v[240:255]
    v_accvgpr_write_b32 a16, v80
    v_accvgpr_write_b32 a17, v81
    v_accvgpr_write_b32 a18, v82
    v_accvgpr_write_b32 a19, v83
    v_mul_f32 v232, v232, v2
    v_mul_f32 v233, v233, v2
    v_mul_f32 v234, v234, v2
    s_waitcnt lgkmcnt(0)
    v_mfma_f32_32x32x16_bf16 v[240:255], a[56:59], v[152:155], v[240:255]
    v_mul_f32 v235, v235, v2
    v_mul_f32 v236, v236, v2
    v_mul_f32 v237, v237, v2
    v_mul_f32 v238, v238, v2
    v_mul_f32 v239, v239, v2
    v_cvt_pk_bf16_f32 v84, v232, v233
    v_cvt_pk_bf16_f32 v85, v234, v235
    v_mfma_f32_32x32x16_bf16 v[240:255], a[60:63], v[156:159], v[240:255]
    v_cvt_pk_bf16_f32 v86, v236, v237
    v_cvt_pk_bf16_f32 v87, v238, v239
    buffer_store_dwordx4 v[84:87], v18, s[20:23], 0 offen offset:1024 sc1
    v_accvgpr_write_b32 a20, v84
    v_accvgpr_write_b32 a21, v85
    v_accvgpr_write_b32 a22, v86
    v_accvgpr_write_b32 a23, v87
    s_nop 4
    v_mul_f32 v240, v240, v2
    v_mul_f32 v241, v241, v2
    v_mul_f32 v242, v242, v2
    v_mul_f32 v243, v243, v2
    v_mul_f32 v244, v244, v2
    v_mul_f32 v245, v245, v2
    v_mul_f32 v246, v246, v2
    v_mul_f32 v247, v247, v2
    v_cvt_pk_bf16_f32 v88, v240, v241
    v_cvt_pk_bf16_f32 v89, v242, v243
    v_cvt_pk_bf16_f32 v90, v244, v245
    v_cvt_pk_bf16_f32 v91, v246, v247
    buffer_store_dwordx4 v[88:91], v18, s[20:23], 0 offen offset:2048 sc1
    v_accvgpr_write_b32 a24, v88
    v_accvgpr_write_b32 a25, v89
    v_accvgpr_write_b32 a26, v90
    v_accvgpr_write_b32 a27, v91
    v_mul_f32 v248, v248, v2
    v_mul_f32 v249, v249, v2
    v_mul_f32 v250, v250, v2
    v_mul_f32 v251, v251, v2
    v_mul_f32 v252, v252, v2
    v_mul_f32 v253, v253, v2
    v_mul_f32 v254, v254, v2
    v_mul_f32 v255, v255, v2
    v_cvt_pk_bf16_f32 v92, v248, v249
    v_cvt_pk_bf16_f32 v93, v250, v251
    v_cvt_pk_bf16_f32 v94, v252, v253
    v_cvt_pk_bf16_f32 v95, v254, v255
    buffer_store_dwordx4 v[92:95], v18, s[20:23], 0 offen offset:3072 sc1
    v_accvgpr_write_b32 a28, v92
    v_accvgpr_write_b32 a29, v93
    v_accvgpr_write_b32 a30, v94
    v_accvgpr_write_b32 a31, v95
    s_mov_b32 s47, 0
L_nonce:
    v_readfirstlane_b32 s96, v160
    v_readfirstlane_b32 s97, v161
    s_nop 2
    s_cmp_lg_u32 s96, 0
    s_cbranch_scc1 L_nonce_ok
    s_add_u32 s47, s47, 1
    s_cmp_gt_u32 s47, 262144
    s_cbranch_scc1 L_nonce_ok
    v_mov_b32 v5, 0
    global_load_dwordx2 v[160:161], v5, s[92:93] sc1
    s_waitcnt vmcnt(0)
    s_branch L_nonce
L_nonce_ok:
    v_lshrrev_b32 v5, 5, v30
    v_lshlrev_b32 v5, 10, v5
    v_bfe_u32 v6, v30, 2, 2
    v_lshl_add_u32 v5, v6, 7, v5
    v_bfe_u32 v6, v30, 3, 1
    v_lshl_add_u32 v5, v6, 6, v5
    v_bfe_u32 v6, v30, 4, 1
    v_lshl_add_u32 v5, v6, 5, v5
    v_and_b32 v6, 1, v30
    v_lshl_add_u32 v5, v6, 4, v5
    v_bfe_u32 v6, v30, 1, 1
    v_lshl_add_u32 v5, v6, 3, v5
    v_add_u32 v19, 0, v5
    v_xor_b32 v20, 64, v19
    v_add_u32 v21, 65536, v5
    v_xor_b32 v22, 64, v21
    v_add_u32 v23, 131072, v5
    v_xor_b32 v24, 64, v23
    s_and_b32 s46, s58, 1
    s_xor_b32 s46, s46, 1
    s_lshl_b32 s46, s46, 6
    v_xor_b32 v5, s46, v5
    v_mov_b32 v166, v5
    s_lshl_b32 s46, s56, 1
    s_sub_u32 s46, 7, s46
    s_cmp_ge_u32 s46, 7
    s_cselect_b32 s47, 7, 0
    s_sub_u32 s46, s46, s47
    s_add_u32 s46, s46, 1
    s_lshl_b32 s46, s46, 14
    v_add_u32 v167, s46, v5
    s_lshl_b32 s46, s56, 1
    s_sub_u32 s46, 8, s46
    s_cmp_ge_u32 s46, 7
    s_cselect_b32 s47, 7, 0
    s_sub_u32 s46, s46, s47
    s_add_u32 s46, s46, 1
    s_lshl_b32 s46, s46, 14
    v_add_u32 v168, s46, v5
    s_lshl_b32 s46, s56, 1
    s_sub_u32 s46, 9, s46
    s_cmp_ge_u32 s46, 7
    s_cselect_b32 s47, 7, 0
    s_sub_u32 s46, s46, s47
    s_add_u32 s46, s46, 1
    s_lshl_b32 s46, s46, 14
    v_add_u32 v169, s46, v5
    s_lshl_b32 s46, s56, 1
    s_sub_u32 s46, 10, s46
    s_cmp_ge_u32 s46, 7
    s_cselect_b32 s47, 7, 0
    s_sub_u32 s46, s46, s47
    s_add_u32 s46, s46, 1
    s_lshl_b32 s46, s46, 14
    v_add_u32 v170, s46, v5
    s_lshl_b32 s46, s56, 1
    s_sub_u32 s46, 11, s46
    s_cmp_ge_u32 s46, 7
    s_cselect_b32 s47, 7, 0
    s_sub_u32 s46, s46, s47
    s_add_u32 s46, s46, 1
    s_lshl_b32 s46, s46, 14
    v_add_u32 v171, s46, v5
    s_lshl_b32 s46, s56, 1
    s_sub_u32 s46, 12, s46
    s_cmp_ge_u32 s46, 7
    s_cselect_b32 s47, 7, 0
    s_sub_u32 s46, s46, s47
    s_add_u32 s46, s46, 1
    s_lshl_b32 s46, s46, 14
    v_add_u32 v172, s46, v5
    s_lshl_b32 s46, s56, 1
    s_sub_u32 s46, 13, s46
    s_cmp_ge_u32 s46, 7
    s_cselect_b32 s47, 7, 0
    s_sub_u32 s46, s46, s47
    s_add_u32 s46, s46, 1
    s_lshl_b32 s46, s46, 14
    v_add_u32 v173, s46, v5
    s_waitcnt vmcnt(0)
    s_barrier
    s_cmp_lg_u32 s24, 0
    s_cbranch_scc1 L_noflag1
    s_lshl_b32 s46, s57, 3
    s_add_u32 s46, s46, s62
    v_mov_b32 v5, s46
    v_mov_b32 v6, s96
    v_mov_b32 v7, s97
    s_mov_b64 s[46:47], exec
    s_mov_b64 exec, 1
    global_store_dwordx2 v5, v[6:7], s[94:95] sc1
    s_mov_b64 exec, s[46:47]
L_noflag1:
    s_mov_b32 s33, 0
    s_add_u32 s33, s33, s57
    s_and_b32 s33, s33, 7
    s_add_u32 m0, s31, 0
    s_lshl_b32 s33, s33, 18
    s_lshl_b32 s34, s60, 7
    s_add_u32 s33, s33, s34
    buffer_load_dwordx4 v162, s[8:11], s33 offen  lds
    buffer_load_dwordx4 v163, s[8:11], s33 offen offset:1024  lds
    buffer_load_dwordx4 v164, s[8:11], s33 offen offset:2048  lds
    buffer_load_dwordx4 v165, s[8:11], s33 offen offset:3072  lds
    s_add_u32 s34, s56, 0
    s_and_b32 s34, s34, 3
    s_add_u32 s34, s34, 4
    s_add_u32 s33, s34, s57
    s_and_b32 s33, s33, 7
    s_lshl_b32 s34, s34, 14
    s_add_u32 s34, s34, s31
    s_add_u32 m0, s34, 32768
    s_lshl_b32 s33, s33, 18
    s_lshl_b32 s34, s59, 7
    s_add_u32 s33, s33, s34
    buffer_load_dwordx4 v162, s[8:11], s33 offen  lds
    buffer_load_dwordx4 v163, s[8:11], s33 offen offset:1024  lds
    buffer_load_dwordx4 v164, s[8:11], s33 offen offset:2048  lds
    buffer_load_dwordx4 v165, s[8:11], s33 offen offset:3072  lds
    s_add_u32 s34, s56, 1
    s_and_b32 s34, s34, 3
    s_add_u32 s34, s34, 4
    s_add_u32 s33, s34, s57
    s_and_b32 s33, s33, 7
    s_lshl_b32 s34, s34, 14
    s_add_u32 s34, s34, s31
    s_add_u32 m0, s34, 32768
    s_lshl_b32 s33, s33, 18
    s_lshl_b32 s34, s59, 7
    s_add_u32 s33, s33, s34
    buffer_load_dwordx4 v162, s[8:11], s33 offen  lds
    buffer_load_dwordx4 v163, s[8:11], s33 offen offset:1024  lds
    buffer_load_dwordx4 v164, s[8:11], s33 offen offset:2048  lds
    buffer_load_dwordx4 v165, s[8:11], s33 offen offset:3072  lds
    s_add_u32 s34, s56, 2
    s_and_b32 s34, s34, 3
    s_add_u32 s34, s34, 4
    s_add_u32 s33, s34, s57
    s_and_b32 s33, s33, 7
    s_lshl_b32 s34, s34, 14
    s_add_u32 s34, s34, s31
    s_add_u32 m0, s34, 32768
    s_lshl_b32 s33, s33, 18
    s_lshl_b32 s34, s59, 7
    s_add_u32 s33, s33, s34
    buffer_load_dwordx4 v162, s[8:11], s33 offen  lds
    buffer_load_dwordx4 v163, s[8:11], s33 offen offset:1024  lds
    buffer_load_dwordx4 v164, s[8:11], s33 offen offset:2048  lds
    buffer_load_dwordx4 v165, s[8:11], s33 offen offset:3072  lds
    s_add_u32 s34, s56, 3
    s_and_b32 s34, s34, 3
    s_add_u32 s34, s34, 4
    s_add_u32 s33, s34, s57
    s_and_b32 s33, s33, 7
    s_lshl_b32 s34, s34, 14
    s_add_u32 s34, s34, s31
    s_add_u32 m0, s34, 32768
    s_lshl_b32 s33, s33, 18
    s_lshl_b32 s34, s59, 7
    s_add_u32 s33, s33, s34
    buffer_load_dwordx4 v162, s[8:11], s33 offen  lds
    buffer_load_dwordx4 v163, s[8:11], s33 offen offset:1024  lds
    buffer_load_dwordx4 v164, s[8:11], s33 offen offset:2048  lds
    buffer_load_dwordx4 v165, s[8:11], s33 offen offset:3072  lds
    s_lshl_b32 s33, s56, 1
    s_add_u32 s33, s33, 0
    s_cmp_ge_u32 s33, 7
    s_cselect_b32 s35, 7, 0
    s_sub_u32 s33, s33, s35
    s_add_u32 s33, s33, 1
    s_add_u32 s33, s33, s57
    s_and_b32 s33, s33, 7
    s_add_u32 m0, s31, 16384
    s_lshl_b32 s33, s33, 18
    s_lshl_b32 s34, s60, 7
    s_add_u32 s33, s33, s34
    buffer_load_dwordx4 v162, s[8:11], s33 offen  lds
    buffer_load_dwordx4 v163, s[8:11], s33 offen offset:1024  lds
    buffer_load_dwordx4 v164, s[8:11], s33 offen offset:2048  lds
    buffer_load_dwordx4 v165, s[8:11], s33 offen offset:3072  lds
    v_and_b32 v10, 7, v30
    v_lshlrev_b32 v10, 3, v10
    v_add_u32 v10, s62, v10
    s_mov_b32 s63, 0
L_poll1:
    global_load_dwordx2 v[8:9], v10, s[94:95] sc1
    s_waitcnt vmcnt(0)
    v_cmp_eq_u32 vcc, s96, v8
    v_cmp_eq_u32 s[50:51], s97, v9
    s_nop 3
    s_and_b64 s[50:51], s[50:51], vcc
    s_and_b32 s50, s50, 0xff
    s_cmp_eq_u32 s50, 0xff
    s_cbranch_scc1 L_poll1_ok
    s_add_u32 s63, s63, 1
    s_cmp_le_u32 s63, 262144
    s_cbranch_scc1 L_poll1
L_poll1_ok:
    s_add_u32 s32, s57, 1
    s_and_b32 s32, s32, 7
    s_lshl_b32 s32, s32, 13
    buffer_load_dwordx4 a[32:35], v17, s[4:7], s32 offen offset:0 sc1
    buffer_load_dwordx4 a[36:39], v17, s[4:7], s32 offen offset:1024 sc1
    buffer_load_dwordx4 a[40:43], v17, s[4:7], s32 offen offset:2048 sc1
    buffer_load_dwordx4 a[44:47], v17, s[4:7], s32 offen offset:3072 sc1
    buffer_load_dwordx4 a[48:51], v18, s[4:7], s32 offen offset:0 sc1
    buffer_load_dwordx4 a[52:55], v18, s[4:7], s32 offen offset:1024 sc1
    buffer_load_dwordx4 a[56:59], v18, s[4:7], s32 offen offset:2048 sc1
    buffer_load_dwordx4 a[60:63], v18, s[4:7], s32 offen offset:3072 sc1
    s_barrier
    v_xor_b32 v6, 64, v166
    ds_read_b64_tr_b16 v[128:129], v19 offset:32768
    ds_read_b64_tr_b16 v[130:131], v19 offset:33280
    ds_read_b64_tr_b16 v[132:133], v20 offset:32768
    ds_read_b64_tr_b16 v[134:135], v20 offset:33280
    ds_read_b64_tr_b16 v[136:137], v166 offset:0
    ds_read_b64_tr_b16 v[138:139], v166 offset:512
    ds_read_b64_tr_b16 v[140:141], v6 offset:0
    ds_read_b64_tr_b16 v[142:143], v6 offset:512
    s_waitcnt lgkmcnt(4)
    v_mfma_f32_32x32x16_bf16 v[64:79], v[128:131], a[0:3], 0
    ds_read_b64_tr_b16 v[144:145], v19 offset:34816
    ds_read_b64_tr_b16 v[146:147], v19 offset:35328
    v_mfma_f32_32x32x16_bf16 v[80:95], v[132:135], a[0:3], 0
    ds_read_b64_tr_b16 v[148:149], v20 offset:34816
    ds_read_b64_tr_b16 v[150:151], v20 offset:35328
    s_add_u32 s32, s57, 2
    s_and_b32 s32, s32, 7
    s_lshl_b32 s32, s32, 13
    buffer_load_dwordx4 a[64:67], v17, s[4:7], s32 offen offset:0 sc1
    s_waitcnt lgkmcnt(4)
    v_mfma_f32_32x32x16_bf16 v[96:111], v[136:139], a[0:3], 0
    ds_read_b64_tr_b16 v[152:153], v166 offset:2048
    ds_read_b64_tr_b16 v[154:155], v166 offset:2560
    v_mfma_f32_32x32x16_bf16 v[112:127], v[140:143], a[0:3], 0
    ds_read_b64_tr_b16 v[156:157], v6 offset:2048
    ds_read_b64_tr_b16 v[158:159], v6 offset:2560
    buffer_load_dwordx4 a[68:71], v17, s[4:7], s32 offen offset:1024 sc1
    s_waitcnt lgkmcnt(4)
    v_mfma_f32_32x32x16_bf16 v[64:79], v[144:147], a[4:7], v[64:79]
    ds_read_b64_tr_b16 v[128:129], v19 offset:36864
    ds_read_b64_tr_b16 v[130:131], v19 offset:37376
    v_mfma_f32_32x32x16_bf16 v[80:95], v[148:151], a[4:7], v[80:95]
    ds_read_b64_tr_b16 v[132:133], v20 offset:36864
    ds_read_b64_tr_b16 v[134:135], v20 offset:37376
    buffer_load_dwordx4 a[72:75], v17, s[4:7], s32 offen offset:2048 sc1
    s_waitcnt lgkmcnt(4)
    v_mfma_f32_32x32x16_bf16 v[96:111], v[152:155], a[4:7], v[96:111]
    ds_read_b64_tr_b16 v[136:137], v166 offset:4096
    ds_read_b64_tr_b16 v[138:139], v166 offset:4608
    v_mfma_f32_32x32x16_bf16 v[112:127], v[156:159], a[4:7], v[112:127]
    ds_read_b64_tr_b16 v[140:141], v6 offset:4096
    ds_read_b64_tr_b16 v[142:143], v6 offset:4608
    buffer_load_dwordx4 a[76:79], v17, s[4:7], s32 offen offset:3072 sc1
    s_waitcnt lgkmcnt(4)
    v_mfma_f32_32x32x16_bf16 v[64:79], v[128:131], a[8:11], v[64:79]
    ds_read_b64_tr_b16 v[144:145], v19 offset:38912
    ds_read_b64_tr_b16 v[146:147], v19 offset:39424
    v_mfma_f32_32x32x16_bf16 v[80:95], v[132:135], a[8:11], v[80:95]
    ds_read_b64_tr_b16 v[148:149], v20 offset:38912
    ds_read_b64_tr_b16 v[150:151], v20 offset:39424
    buffer_load_dwordx4 a[80:83], v18, s[4:7], s32 offen offset:0 sc1
    s_waitcnt lgkmcnt(4)
    v_mfma_f32_32x32x16_bf16 v[96:111], v[136:139], a[8:11], v[96:111]
    ds_read_b64_tr_b16 v[152:153], v166 offset:6144
    ds_read_b64_tr_b16 v[154:155], v166 offset:6656
    v_mfma_f32_32x32x16_bf16 v[112:127], v[140:143], a[8:11], v[112:127]
    ds_read_b64_tr_b16 v[156:157], v6 offset:6144
    ds_read_b64_tr_b16 v[158:159], v6 offset:6656
    buffer_load_dwordx4 a[84:87], v18, s[4:7], s32 offen offset:1024 sc1
    s_waitcnt lgkmcnt(4)
    v_mfma_f32_32x32x16_bf16 v[64:79], v[144:147], a[12:15], v[64:79]
    ds_read_b64_tr_b16 v[128:129], v19 offset:40960
    ds_read_b64_tr_b16 v[130:131], v19 offset:41472
    v_mfma_f32_32x32x16_bf16 v[80:95], v[148:151], a[12:15], v[80:95]
    ds_read_b64_tr_b16 v[132:133], v20 offset:40960
    ds_read_b64_tr_b16 v[134:135], v20 offset:41472
    buffer_load_dwordx4 a[88:91], v18, s[4:7], s32 offen offset:2048 sc1
    s_waitcnt lgkmcnt(4)
    v_mfma_f32_32x32x16_bf16 v[96:111], v[152:155], a[12:15], v[96:111]
    ds_read_b64_tr_b16 v[136:137], v166 offset:8192
    ds_read_b64_tr_b16 v[138:139], v166 offset:8704
    v_mfma_f32_32x32x16_bf16 v[112:127], v[156:159], a[12:15], v[112:127]
    ds_read_b64_tr_b16 v[140:141], v6 offset:8192
    ds_read_b64_tr_b16 v[142:143], v6 offset:8704
    buffer_load_dwordx4 a[92:95], v18, s[4:7], s32 offen offset:3072 sc1
    s_waitcnt lgkmcnt(4)
    v_mfma_f32_32x32x16_bf16 v[64:79], v[128:131], a[16:19], v[64:79]
    ds_read_b64_tr_b16 v[144:145], v19 offset:43008
    ds_read_b64_tr_b16 v[146:147], v19 offset:43520
    v_mfma_f32_32x32x16_bf16 v[80:95], v[132:135], a[16:19], v[80:95]
    ds_read_b64_tr_b16 v[148:149], v20 offset:43008
    ds_read_b64_tr_b16 v[150:151], v20 offset:43520
    s_add_u32 s32, s57, 3
    s_and_b32 s32, s32, 7
    s_lshl_b32 s32, s32, 13
    buffer_load_dwordx4 a[96:99], v17, s[4:7], s32 offen offset:0 sc1
    s_waitcnt lgkmcnt(4)
    v_mfma_f32_32x32x16_bf16 v[96:111], v[136:139], a[16:19], v[96:111]
    ds_read_b64_tr_b16 v[152:153], v166 offset:10240
    ds_read_b64_tr_b16 v[154:155], v166 offset:10752
    v_mfma_f32_32x32x16_bf16 v[112:127], v[140:143], a[16:19], v[112:127]
    ds_read_b64_tr_b16 v[156:157], v6 offset:10240
    ds_read_b64_tr_b16 v[158:159], v6 offset:10752
    buffer_load_dwordx4 a[100:103], v17, s[4:7], s32 offen offset:1024 sc1
    s_waitcnt lgkmcnt(4)
    v_mfma_f32_32x32x16_bf16 v[64:79], v[144:147], a[20:23], v[64:79]
    ds_read_b64_tr_b16 v[128:129], v19 offset:45056
    ds_read_b64_tr_b16 v[130:131], v19 offset:45568
    v_mfma_f32_32x32x16_bf16 v[80:95], v[148:151], a[20:23], v[80:95]
    ds_read_b64_tr_b16 v[132:133], v20 offset:45056
    ds_read_b64_tr_b16 v[134:135], v20 offset:45568
    buffer_load_dwordx4 a[104:107], v17, s[4:7], s32 offen offset:2048 sc1
    s_waitcnt lgkmcnt(4)
    v_mfma_f32_32x32x16_bf16 v[96:111], v[152:155], a[20:23], v[96:111]
    ds_read_b64_tr_b16 v[136:137], v166 offset:12288
    ds_read_b64_tr_b16 v[138:139], v166 offset:12800
    v_mfma_f32_32x32x16_bf16 v[112:127], v[156:159], a[20:23], v[112:127]
    ds_read_b64_tr_b16 v[140:141], v6 offset:12288
    ds_read_b64_tr_b16 v[142:143], v6 offset:12800
    buffer_load_dwordx4 a[108:111], v17, s[4:7], s32 offen offset:3072 sc1
    s_waitcnt lgkmcnt(4)
    v_mfma_f32_32x32x16_bf16 v[64:79], v[128:131], a[24:27], v[64:79]
    ds_read_b64_tr_b16 v[144:145], v19 offset:47104
    ds_read_b64_tr_b16 v[146:147], v19 offset:47616
    v_mfma_f32_32x32x16_bf16 v[80:95], v[132:135], a[24:27], v[80:95]
    ds_read_b64_tr_b16 v[148:149], v20 offset:47104
    ds_read_b64_tr_b16 v[150:151], v20 offset:47616
    buffer_load_dwordx4 a[112:115], v18, s[4:7], s32 offen offset:0 sc1
    s_waitcnt lgkmcnt(4)
    v_mfma_f32_32x32x16_bf16 v[96:111], v[136:139], a[24:27], v[96:111]
    ds_read_b64_tr_b16 v[152:153], v166 offset:14336
    ds_read_b64_tr_b16 v[154:155], v166 offset:14848
    v_mfma_f32_32x32x16_bf16 v[112:127], v[140:143], a[24:27], v[112:127]
    ds_read_b64_tr_b16 v[156:157], v6 offset:14336
    ds_read_b64_tr_b16 v[158:159], v6 offset:14848
    buffer_load_dwordx4 a[116:119], v18, s[4:7], s32 offen offset:1024 sc1
    s_waitcnt lgkmcnt(4)
    v_mfma_f32_32x32x16_bf16 v[64:79], v[144:147], a[28:31], v[64:79]
    v_mfma_f32_32x32x16_bf16 v[80:95], v[148:151], a[28:31], v[80:95]
    buffer_load_dwordx4 a[120:123], v18, s[4:7], s32 offen offset:2048 sc1
    s_waitcnt lgkmcnt(0)
    v_mfma_f32_32x32x16_bf16 v[96:111], v[152:155], a[28:31], v[96:111]
    v_mfma_f32_32x32x16_bf16 v[112:127], v[156:159], a[28:31], v[112:127]
    buffer_load_dwordx4 a[124:127], v18, s[4:7], s32 offen offset:3072 sc1
    ds_read_b64_tr_b16 v[128:129], v19 offset:49152
    ds_read_b64_tr_b16 v[130:131], v19 offset:49664
    ds_read_b64_tr_b16 v[132:133], v20 offset:49152
    ds_read_b64_tr_b16 v[134:135], v20 offset:49664
    ds_read_b64_tr_b16 v[136:137], v19 offset:51200
    ds_read_b64_tr_b16 v[138:139], v19 offset:51712
    ds_read_b64_tr_b16 v[140:141], v20 offset:51200
    ds_read_b64_tr_b16 v[142:143], v20 offset:51712
    ds_read_b64_tr_b16 v[144:145], v19 offset:53248
    ds_read_b64_tr_b16 v[146:147], v19 offset:53760
    ds_read_b64_tr_b16 v[148:149], v20 offset:53248
    ds_read_b64_tr_b16 v[150:151], v20 offset:53760
    s_waitcnt vmcnt(16)
    s_waitcnt lgkmcnt(8)
    v_mfma_f32_32x32x16_bf16 v[64:79], v[128:131], a[32:35], v[64:79]
    ds_read_b64_tr_b16 v[152:153], v19 offset:55296
    ds_read_b64_tr_b16 v[154:155], v19 offset:55808
    v_mfma_f32_32x32x16_bf16 v[80:95], v[132:135], a[32:35], v[80:95]
    ds_read_b64_tr_b16 v[156:157], v20 offset:55296
    ds_read_b64_tr_b16 v[158:159], v20 offset:55808
    s_add_u32 s32, s57, 4
    s_and_b32 s32, s32, 7
    s_lshl_b32 s32, s32, 13
    buffer_load_dwordx4 a[128:131], v17, s[4:7], s32 offen offset:0 sc1
    s_waitcnt lgkmcnt(8)
    v_mfma_f32_32x32x16_bf16 v[64:79], v[136:139], a[36:39], v[64:79]
    ds_read_b64_tr_b16 v[128:129], v19 offset:57344
    ds_read_b64_tr_b16 v[130:131], v19 offset:57856
    v_mfma_f32_32x32x16_bf16 v[80:95], v[140:143], a[36:39], v[80:95]
    ds_read_b64_tr_b16 v[132:133], v20 offset:57344
    ds_read_b64_tr_b16 v[134:135], v20 offset:57856
    buffer_load_dwordx4 a[132:135], v17, s[4:7], s32 offen offset:1024 sc1
    s_waitcnt lgkmcnt(8)
    v_mfma_f32_32x32x16_bf16 v[64:79], v[144:147], a[40:43], v[64:79]
    ds_read_b64_tr_b16 v[136:137], v19 offset:59392
    ds_read_b64_tr_b16 v[138:139], v19 offset:59904
    v_mfma_f32_32x32x16_bf16 v[80:95], v[148:151], a[40:43], v[80:95]
    ds_read_b64_tr_b16 v[140:141], v20 offset:59392
    ds_read_b64_tr_b16 v[142:143], v20 offset:59904
    buffer_load_dwordx4 a[136:139], v17, s[4:7], s32 offen offset:2048 sc1
    s_waitcnt lgkmcnt(8)
    v_mfma_f32_32x32x16_bf16 v[64:79], v[152:155], a[44:47], v[64:79]
    ds_read_b64_tr_b16 v[144:145], v19 offset:61440
    ds_read_b64_tr_b16 v[146:147], v19 offset:61952
    v_mfma_f32_32x32x16_bf16 v[80:95], v[156:159], a[44:47], v[80:95]
    ds_read_b64_tr_b16 v[148:149], v20 offset:61440
    ds_read_b64_tr_b16 v[150:151], v20 offset:61952
    buffer_load_dwordx4 a[140:143], v17, s[4:7], s32 offen offset:3072 sc1
    s_waitcnt lgkmcnt(8)
    v_mfma_f32_32x32x16_bf16 v[64:79], v[128:131], a[48:51], v[64:79]
    ds_read_b64_tr_b16 v[152:153], v19 offset:63488
    ds_read_b64_tr_b16 v[154:155], v19 offset:64000
    v_mfma_f32_32x32x16_bf16 v[80:95], v[132:135], a[48:51], v[80:95]
    ds_read_b64_tr_b16 v[156:157], v20 offset:63488
    ds_read_b64_tr_b16 v[158:159], v20 offset:64000
    buffer_load_dwordx4 a[144:147], v18, s[4:7], s32 offen offset:0 sc1
    s_waitcnt lgkmcnt(8)
    v_mfma_f32_32x32x16_bf16 v[64:79], v[136:139], a[52:55], v[64:79]
    ds_read_b64_tr_b16 v[128:129], v21 offset:0
    ds_read_b64_tr_b16 v[130:131], v21 offset:512
    v_mfma_f32_32x32x16_bf16 v[80:95], v[140:143], a[52:55], v[80:95]
    ds_read_b64_tr_b16 v[132:133], v22 offset:0
    ds_read_b64_tr_b16 v[134:135], v22 offset:512
    buffer_load_dwordx4 a[148:151], v18, s[4:7], s32 offen offset:1024 sc1
    s_waitcnt lgkmcnt(8)
    v_mfma_f32_32x32x16_bf16 v[64:79], v[144:147], a[56:59], v[64:79]
    ds_read_b64_tr_b16 v[136:137], v21 offset:2048
    ds_read_b64_tr_b16 v[138:139], v21 offset:2560
    v_mfma_f32_32x32x16_bf16 v[80:95], v[148:151], a[56:59], v[80:95]
    ds_read_b64_tr_b16 v[140:141], v22 offset:2048
    ds_read_b64_tr_b16 v[142:143], v22 offset:2560
    buffer_load_dwordx4 a[152:155], v18, s[4:7], s32 offen offset:2048 sc1
    s_waitcnt lgkmcnt(8)
    v_mfma_f32_32x32x16_bf16 v[64:79], v[152:155], a[60:63], v[64:79]
    ds_read_b64_tr_b16 v[144:145], v21 offset:4096
    ds_read_b64_tr_b16 v[146:147], v21 offset:4608
    v_mfma_f32_32x32x16_bf16 v[80:95], v[156:159], a[60:63], v[80:95]
    ds_read_b64_tr_b16 v[148:149], v22 offset:4096
    ds_read_b64_tr_b16 v[150:151], v22 offset:4608
    buffer_load_dwordx4 a[156:159], v18, s[4:7], s32 offen offset:3072 sc1
    s_barrier
    s_waitcnt vmcnt(16)
    s_waitcnt lgkmcnt(8)
    v_mfma_f32_32x32x16_bf16 v[64:79], v[128:131], a[64:67], v[64:79]
    ds_read_b64_tr_b16 v[152:153], v21 offset:6144
    ds_read_b64_tr_b16 v[154:155], v21 offset:6656
    s_add_u32 s32, s57, 5
    s_and_b32 s32, s32, 7
    s_lshl_b32 s32, s32, 13
    buffer_load_dwordx4 a[160:163], v17, s[4:7], s32 offen offset:0 sc1
    v_mfma_f32_32x32x16_bf16 v[80:95], v[132:135], a[64:67], v[80:95]
    ds_read_b64_tr_b16 v[156:157], v22 offset:6144
    ds_read_b64_tr_b16 v[158:159], v22 offset:6656
    buffer_load_dwordx4 a[164:167], v17, s[4:7], s32 offen offset:1024 sc1
    s_waitcnt lgkmcnt(8)
    v_mfma_f32_32x32x16_bf16 v[64:79], v[136:139], a[68:71], v[64:79]
    ds_read_b64_tr_b16 v[128:129], v21 offset:8192
    ds_read_b64_tr_b16 v[130:131], v21 offset:8704
    buffer_load_dwordx4 a[168:171], v17, s[4:7], s32 offen offset:2048 sc1
    v_mfma_f32_32x32x16_bf16 v[80:95], v[140:143], a[68:71], v[80:95]
    ds_read_b64_tr_b16 v[132:133], v22 offset:8192
    ds_read_b64_tr_b16 v[134:135], v22 offset:8704
    buffer_load_dwordx4 a[172:175], v17, s[4:7], s32 offen offset:3072 sc1
    s_waitcnt lgkmcnt(8)
    v_mfma_f32_32x32x16_bf16 v[64:79], v[144:147], a[72:75], v[64:79]
    ds_read_b64_tr_b16 v[136:137], v21 offset:10240
    ds_read_b64_tr_b16 v[138:139], v21 offset:10752
    buffer_load_dwordx4 a[176:179], v18, s[4:7], s32 offen offset:0 sc1
    v_mfma_f32_32x32x16_bf16 v[80:95], v[148:151], a[72:75], v[80:95]
    ds_read_b64_tr_b16 v[140:141], v22 offset:10240
    ds_read_b64_tr_b16 v[142:143], v22 offset:10752
    buffer_load_dwordx4 a[180:183], v18, s[4:7], s32 offen offset:1024 sc1
    s_waitcnt lgkmcnt(8)
    v_mfma_f32_32x32x16_bf16 v[64:79], v[152:155], a[76:79], v[64:79]
    ds_read_b64_tr_b16 v[144:145], v21 offset:12288
    ds_read_b64_tr_b16 v[146:147], v21 offset:12800
    buffer_load_dwordx4 a[184:187], v18, s[4:7], s32 offen offset:2048 sc1
    v_mfma_f32_32x32x16_bf16 v[80:95], v[156:159], a[76:79], v[80:95]
    ds_read_b64_tr_b16 v[148:149], v22 offset:12288
    ds_read_b64_tr_b16 v[150:151], v22 offset:12800
    buffer_load_dwordx4 a[188:191], v18, s[4:7], s32 offen offset:3072 sc1
    s_waitcnt lgkmcnt(8)
    v_mfma_f32_32x32x16_bf16 v[64:79], v[128:131], a[80:83], v[64:79]
    ds_read_b64_tr_b16 v[152:153], v21 offset:14336
    ds_read_b64_tr_b16 v[154:155], v21 offset:14848
    s_lshl_b32 s33, s56, 1
    s_add_u32 s33, s33, 1
    s_cmp_ge_u32 s33, 7
    s_cselect_b32 s35, 7, 0
    s_sub_u32 s33, s33, s35
    s_add_u32 s33, s33, 1
    s_add_u32 s33, s33, s57
    s_and_b32 s33, s33, 7
    s_add_u32 m0, s31, 32768
    s_lshl_b32 s33, s33, 18
    s_lshl_b32 s34, s60, 7
    s_add_u32 s33, s33, s34
    buffer_load_dwordx4 v162, s[8:11], s33 offen  lds
    v_mfma_f32_32x32x16_bf16 v[80:95], v[132:135], a[80:83], v[80:95]
    ds_read_b64_tr_b16 v[156:157], v22 offset:14336
    ds_read_b64_tr_b16 v[158:159], v22 offset:14848
    buffer_load_dwordx4 v163, s[8:11], s33 offen offset:1024  lds
    s_waitcnt lgkmcnt(8)
    v_mfma_f32_32x32x16_bf16 v[64:79], v[136:139], a[84:87], v[64:79]
    ds_read_b64_tr_b16 v[128:129], v21 offset:16384
    ds_read_b64_tr_b16 v[130:131], v21 offset:16896
    buffer_load_dwordx4 v164, s[8:11], s33 offen offset:2048  lds
    v_mfma_f32_32x32x16_bf16 v[80:95], v[140:143], a[84:87], v[80:95]
    ds_read_b64_tr_b16 v[132:133], v22 offset:16384
    ds_read_b64_tr_b16 v[134:135], v22 offset:16896
    buffer_load_dwordx4 v165, s[8:11], s33 offen offset:3072  lds
    s_waitcnt lgkmcnt(8)
    v_mfma_f32_32x32x16_bf16 v[64:79], v[144:147], a[88:91], v[64:79]
    ds_read_b64_tr_b16 v[136:137], v21 offset:18432
    ds_read_b64_tr_b16 v[138:139], v21 offset:18944
    s_lshl_b32 s33, s56, 1
    s_add_u32 s33, s33, 2
    s_cmp_ge_u32 s33, 7
    s_cselect_b32 s35, 7, 0
    s_sub_u32 s33, s33, s35
    s_add_u32 s33, s33, 1
    s_add_u32 s33, s33, s57
    s_and_b32 s33, s33, 7
    s_add_u32 m0, s31, 49152
    s_lshl_b32 s33, s33, 18
    s_lshl_b32 s34, s60, 7
    s_add_u32 s33, s33, s34
    buffer_load_dwordx4 v162, s[8:11], s33 offen  lds
    v_mfma_f32_32x32x16_bf16 v[80:95], v[148:151], a[88:91], v[80:95]
    ds_read_b64_tr_b16 v[140:141], v22 offset:18432
    ds_read_b64_tr_b16 v[142:143], v22 offset:18944
    buffer_load_dwordx4 v163, s[8:11], s33 offen offset:1024  lds
    s_waitcnt lgkmcnt(8)
    v_mfma_f32_32x32x16_bf16 v[64:79], v[152:155], a[92:95], v[64:79]
    ds_read_b64_tr_b16 v[144:145], v21 offset:20480
    ds_read_b64_tr_b16 v[146:147], v21 offset:20992
    buffer_load_dwordx4 v164, s[8:11], s33 offen offset:2048  lds
    v_mfma_f32_32x32x16_bf16 v[80:95], v[156:159], a[92:95], v[80:95]
    ds_read_b64_tr_b16 v[148:149], v22 offset:20480
    ds_read_b64_tr_b16 v[150:151], v22 offset:20992
    buffer_load_dwordx4 v165, s[8:11], s33 offen offset:3072  lds
    s_waitcnt vmcnt(24)
    s_waitcnt lgkmcnt(8)
    v_mfma_f32_32x32x16_bf16 v[64:79], v[128:131], a[96:99], v[64:79]
    ds_read_b64_tr_b16 v[152:153], v21 offset:22528
    ds_read_b64_tr_b16 v[154:155], v21 offset:23040
    v_mfma_f32_32x32x16_bf16 v[80:95], v[132:135], a[96:99], v[80:95]
    ds_read_b64_tr_b16 v[156:157], v22 offset:22528
    ds_read_b64_tr_b16 v[158:159], v22 offset:23040
    s_add_u32 s32, s57, 6
    s_and_b32 s32, s32, 7
    s_lshl_b32 s32, s32, 13
    buffer_load_dwordx4 a[192:195], v17, s[4:7], s32 offen offset:0 sc1
    s_waitcnt lgkmcnt(8)
    v_mfma_f32_32x32x16_bf16 v[64:79], v[136:139], a[100:103], v[64:79]
    ds_read_b64_tr_b16 v[128:129], v21 offset:24576
    ds_read_b64_tr_b16 v[130:131], v21 offset:25088
    v_mfma_f32_32x32x16_bf16 v[80:95], v[140:143], a[100:103], v[80:95]
    ds_read_b64_tr_b16 v[132:133], v22 offset:24576
    ds_read_b64_tr_b16 v[134:135], v22 offset:25088
    buffer_load_dwordx4 a[196:199], v17, s[4:7], s32 offen offset:1024 sc1
    s_waitcnt lgkmcnt(8)
    v_mfma_f32_32x32x16_bf16 v[64:79], v[144:147], a[104:107], v[64:79]
    ds_read_b64_tr_b16 v[136:137], v21 offset:26624
    ds_read_b64_tr_b16 v[138:139], v21 offset:27136
    v_mfma_f32_32x32x16_bf16 v[80:95], v[148:151], a[104:107], v[80:95]
    ds_read_b64_tr_b16 v[140:141], v22 offset:26624
    ds_read_b64_tr_b16 v[142:143], v22 offset:27136
    buffer_load_dwordx4 a[200:203], v17, s[4:7], s32 offen offset:2048 sc1
    s_waitcnt lgkmcnt(8)
    v_mfma_f32_32x32x16_bf16 v[64:79], v[152:155], a[108:111], v[64:79]
    ds_read_b64_tr_b16 v[144:145], v21 offset:28672
    ds_read_b64_tr_b16 v[146:147], v21 offset:29184
    v_mfma_f32_32x32x16_bf16 v[80:95], v[156:159], a[108:111], v[80:95]
    ds_read_b64_tr_b16 v[148:149], v22 offset:28672
    ds_read_b64_tr_b16 v[150:151], v22 offset:29184
    buffer_load_dwordx4 a[204:207], v17, s[4:7], s32 offen offset:3072 sc1
    s_waitcnt lgkmcnt(8)
    v_mfma_f32_32x32x16_bf16 v[64:79], v[128:131], a[112:115], v[64:79]
    ds_read_b64_tr_b16 v[152:153], v21 offset:30720
    ds_read_b64_tr_b16 v[154:155], v21 offset:31232
    v_mfma_f32_32x32x16_bf16 v[80:95], v[132:135], a[112:115], v[80:95]
    ds_read_b64_tr_b16 v[156:157], v22 offset:30720
    ds_read_b64_tr_b16 v[158:159], v22 offset:31232
    buffer_load_dwordx4 a[208:211], v18, s[4:7], s32 offen offset:0 sc1
    s_waitcnt lgkmcnt(8)
    v_mfma_f32_32x32x16_bf16 v[64:79], v[136:139], a[116:119], v[64:79]
    ds_read_b64_tr_b16 v[128:129], v21 offset:32768
    ds_read_b64_tr_b16 v[130:131], v21 offset:33280
    v_mfma_f32_32x32x16_bf16 v[80:95], v[140:143], a[116:119], v[80:95]
    ds_read_b64_tr_b16 v[132:133], v22 offset:32768
    ds_read_b64_tr_b16 v[134:135], v22 offset:33280
    buffer_load_dwordx4 a[212:215], v18, s[4:7], s32 offen offset:1024 sc1
    s_waitcnt lgkmcnt(8)
    v_mfma_f32_32x32x16_bf16 v[64:79], v[144:147], a[120:123], v[64:79]
    ds_read_b64_tr_b16 v[136:137], v21 offset:34816
    ds_read_b64_tr_b16 v[138:139], v21 offset:35328
    v_mfma_f32_32x32x16_bf16 v[80:95], v[148:151], a[120:123], v[80:95]
    ds_read_b64_tr_b16 v[140:141], v22 offset:34816
    ds_read_b64_tr_b16 v[142:143], v22 offset:35328
    buffer_load_dwordx4 a[216:219], v18, s[4:7], s32 offen offset:2048 sc1
    s_waitcnt lgkmcnt(8)
    v_mfma_f32_32x32x16_bf16 v[64:79], v[152:155], a[124:127], v[64:79]
    ds_read_b64_tr_b16 v[144:145], v21 offset:36864
    ds_read_b64_tr_b16 v[146:147], v21 offset:37376
    v_mfma_f32_32x32x16_bf16 v[80:95], v[156:159], a[124:127], v[80:95]
    ds_read_b64_tr_b16 v[148:149], v22 offset:36864
    ds_read_b64_tr_b16 v[150:151], v22 offset:37376
    buffer_load_dwordx4 a[220:223], v18, s[4:7], s32 offen offset:3072 sc1
    s_barrier
    s_waitcnt vmcnt(24)
    s_waitcnt lgkmcnt(8)
    v_mfma_f32_32x32x16_bf16 v[64:79], v[128:131], a[128:131], v[64:79]
    ds_read_b64_tr_b16 v[152:153], v21 offset:38912
    ds_read_b64_tr_b16 v[154:155], v21 offset:39424
    s_add_u32 s32, s57, 7
    s_and_b32 s32, s32, 7
    s_lshl_b32 s32, s32, 13
    buffer_load_dwordx4 a[224:227], v17, s[4:7], s32 offen offset:0 sc1
    v_mfma_f32_32x32x16_bf16 v[80:95], v[132:135], a[128:131], v[80:95]
    ds_read_b64_tr_b16 v[156:157], v22 offset:38912
    ds_read_b64_tr_b16 v[158:159], v22 offset:39424
    buffer_load_dwordx4 a[228:231], v17, s[4:7], s32 offen offset:1024 sc1
    s_waitcnt lgkmcnt(8)
    v_mfma_f32_32x32x16_bf16 v[64:79], v[136:139], a[132:135], v[64:79]
    ds_read_b64_tr_b16 v[128:129], v21 offset:40960
    ds_read_b64_tr_b16 v[130:131], v21 offset:41472
    buffer_load_dwordx4 a[232:235], v17, s[4:7], s32 offen offset:2048 sc1
    v_mfma_f32_32x32x16_bf16 v[80:95], v[140:143], a[132:135], v[80:95]
    ds_read_b64_tr_b16 v[132:133], v22 offset:40960
    ds_read_b64_tr_b16 v[134:135], v22 offset:41472
    buffer_load_dwordx4 a[236:239], v17, s[4:7], s32 offen offset:3072 sc1
    s_waitcnt lgkmcnt(8)
    v_mfma_f32_32x32x16_bf16 v[64:79], v[144:147], a[136:139], v[64:79]
    ds_read_b64_tr_b16 v[136:137], v21 offset:43008
    ds_read_b64_tr_b16 v[138:139], v21 offset:43520
    buffer_load_dwordx4 a[240:243], v18, s[4:7], s32 offen offset:0 sc1
    v_mfma_f32_32x32x16_bf16 v[80:95], v[148:151], a[136:139], v[80:95]
    ds_read_b64_tr_b16 v[140:141], v22 offset:43008
    ds_read_b64_tr_b16 v[142:143], v22 offset:43520
    buffer_load_dwordx4 a[244:247], v18, s[4:7], s32 offen offset:1024 sc1
    s_waitcnt lgkmcnt(8)
    v_mfma_f32_32x32x16_bf16 v[64:79], v[152:155], a[140:143], v[64:79]
    ds_read_b64_tr_b16 v[144:145], v21 offset:45056
    ds_read_b64_tr_b16 v[146:147], v21 offset:45568
    buffer_load_dwordx4 a[248:251], v18, s[4:7], s32 offen offset:2048 sc1
    v_mfma_f32_32x32x16_bf16 v[80:95], v[156:159], a[140:143], v[80:95]
    ds_read_b64_tr_b16 v[148:149], v22 offset:45056
    ds_read_b64_tr_b16 v[150:151], v22 offset:45568
    buffer_load_dwordx4 a[252:255], v18, s[4:7], s32 offen offset:3072 sc1
    s_waitcnt lgkmcnt(8)
    v_mfma_f32_32x32x16_bf16 v[64:79], v[128:131], a[144:147], v[64:79]
    ds_read_b64_tr_b16 v[152:153], v21 offset:47104
    ds_read_b64_tr_b16 v[154:155], v21 offset:47616
    s_lshl_b32 s33, s56, 1
    s_add_u32 s33, s33, 3
    s_cmp_ge_u32 s33, 7
    s_cselect_b32 s35, 7, 0
    s_sub_u32 s33, s33, s35
    s_add_u32 s33, s33, 1
    s_add_u32 s33, s33, s57
    s_and_b32 s33, s33, 7
    s_add_u32 m0, s31, 65536
    s_lshl_b32 s33, s33, 18
    s_lshl_b32 s34, s60, 7
    s_add_u32 s33, s33, s34
    buffer_load_dwordx4 v162, s[8:11], s33 offen  lds
    v_mfma_f32_32x32x16_bf16 v[80:95], v[132:135], a[144:147], v[80:95]
    ds_read_b64_tr_b16 v[156:157], v22 offset:47104
    ds_read_b64_tr_b16 v[158:159], v22 offset:47616
    buffer_load_dwordx4 v163, s[8:11], s33 offen offset:1024  lds
    s_waitcnt lgkmcnt(8)
    v_mfma_f32_32x32x16_bf16 v[64:79], v[136:139], a[148:151], v[64:79]
    ds_read_b64_tr_b16 v[128:129], v21 offset:49152
    ds_read_b64_tr_b16 v[130:131], v21 offset:49664
    buffer_load_dwordx4 v164, s[8:11], s33 offen offset:2048  lds
    v_mfma_f32_32x32x16_bf16 v[80:95], v[140:143], a[148:151], v[80:95]
    ds_read_b64_tr_b16 v[132:133], v22 offset:49152
    ds_read_b64_tr_b16 v[134:135], v22 offset:49664
    buffer_load_dwordx4 v165, s[8:11], s33 offen offset:3072  lds
    s_waitcnt lgkmcnt(8)
    v_mfma_f32_32x32x16_bf16 v[64:79], v[144:147], a[152:155], v[64:79]
    ds_read_b64_tr_b16 v[136:137], v21 offset:51200
    ds_read_b64_tr_b16 v[138:139], v21 offset:51712
    s_lshl_b32 s33, s56, 1
    s_add_u32 s33, s33, 4
    s_cmp_ge_u32 s33, 7
    s_cselect_b32 s35, 7, 0
    s_sub_u32 s33, s33, s35
    s_add_u32 s33, s33, 1
    s_add_u32 s33, s33, s57
    s_and_b32 s33, s33, 7
    s_add_u32 m0, s31, 81920
    s_lshl_b32 s33, s33, 18
    s_lshl_b32 s34, s60, 7
    s_add_u32 s33, s33, s34
    buffer_load_dwordx4 v162, s[8:11], s33 offen  lds
    v_mfma_f32_32x32x16_bf16 v[80:95], v[148:151], a[152:155], v[80:95]
    ds_read_b64_tr_b16 v[140:141], v22 offset:51200
    ds_read_b64_tr_b16 v[142:143], v22 offset:51712
    buffer_load_dwordx4 v163, s[8:11], s33 offen offset:1024  lds
    s_waitcnt lgkmcnt(8)
    v_mfma_f32_32x32x16_bf16 v[64:79], v[152:155], a[156:159], v[64:79]
    ds_read_b64_tr_b16 v[144:145], v21 offset:53248
    ds_read_b64_tr_b16 v[146:147], v21 offset:53760
    buffer_load_dwordx4 v164, s[8:11], s33 offen offset:2048  lds
    v_mfma_f32_32x32x16_bf16 v[80:95], v[156:159], a[156:159], v[80:95]
    ds_read_b64_tr_b16 v[148:149], v22 offset:53248
    ds_read_b64_tr_b16 v[150:151], v22 offset:53760
    buffer_load_dwordx4 v165, s[8:11], s33 offen offset:3072  lds
    s_waitcnt vmcnt(32)
    s_waitcnt lgkmcnt(8)
    v_mfma_f32_32x32x16_bf16 v[64:79], v[128:131], a[160:163], v[64:79]
    ds_read_b64_tr_b16 v[152:153], v21 offset:55296
    ds_read_b64_tr_b16 v[154:155], v21 offset:55808
    v_mfma_f32_32x32x16_bf16 v[80:95], v[132:135], a[160:163], v[80:95]
    ds_read_b64_tr_b16 v[156:157], v22 offset:55296
    ds_read_b64_tr_b16 v[158:159], v22 offset:55808
    s_waitcnt lgkmcnt(8)
    v_mfma_f32_32x32x16_bf16 v[64:79], v[136:139], a[164:167], v[64:79]
    ds_read_b64_tr_b16 v[128:129], v21 offset:57344
    ds_read_b64_tr_b16 v[130:131], v21 offset:57856
    v_mfma_f32_32x32x16_bf16 v[80:95], v[140:143], a[164:167], v[80:95]
    ds_read_b64_tr_b16 v[132:133], v22 offset:57344
    ds_read_b64_tr_b16 v[134:135], v22 offset:57856
    s_waitcnt lgkmcnt(8)
    v_mfma_f32_32x32x16_bf16 v[64:79], v[144:147], a[168:171], v[64:79]
    ds_read_b64_tr_b16 v[136:137], v21 offset:59392
    ds_read_b64_tr_b16 v[138:139], v21 offset:59904
    v_mfma_f32_32x32x16_bf16 v[80:95], v[148:151], a[168:171], v[80:95]
    ds_read_b64_tr_b16 v[140:141], v22 offset:59392
    ds_read_b64_tr_b16 v[142:143], v22 offset:59904
    s_waitcnt lgkmcnt(8)
    v_mfma_f32_32x32x16_bf16 v[64:79], v[152:155], a[172:175], v[64:79]
    ds_read_b64_tr_b16 v[144:145], v21 offset:61440
    ds_read_b64_tr_b16 v[146:147], v21 offset:61952
    v_mfma_f32_32x32x16_bf16 v[80:95], v[156:159], a[172:175], v[80:95]
    ds_read_b64_tr_b16 v[148:149], v22 offset:61440
    ds_read_b64_tr_b16 v[150:151], v22 offset:61952
    s_waitcnt lgkmcnt(8)
    v_mfma_f32_32x32x16_bf16 v[64:79], v[128:131], a[176:179], v[64:79]
    ds_read_b64_tr_b16 v[152:153], v21 offset:63488
    ds_read_b64_tr_b16 v[154:155], v21 offset:64000
    v_mfma_f32_32x32x16_bf16 v[80:95], v[132:135], a[176:179], v[80:95]
    ds_read_b64_tr_b16 v[156:157], v22 offset:63488
    ds_read_b64_tr_b16 v[158:159], v22 offset:64000
    s_waitcnt lgkmcnt(8)
    v_mfma_f32_32x32x16_bf16 v[64:79], v[136:139], a[180:183], v[64:79]
    ds_read_b64_tr_b16 v[128:129], v23 offset:0
    ds_read_b64_tr_b16 v[130:131], v23 offset:512
    v_mfma_f32_32x32x16_bf16 v[80:95], v[140:143], a[180:183], v[80:95]
    ds_read_b64_tr_b16 v[132:133], v24 offset:0
    ds_read_b64_tr_b16 v[134:135], v24 offset:512
    s_waitcnt lgkmcnt(8)
    v_mfma_f32_32x32x16_bf16 v[64:79], v[144:147], a[184:187], v[64:79]
    ds_read_b64_tr_b16 v[136:137], v23 offset:2048
    ds_read_b64_tr_b16 v[138:139], v23 offset:2560
    v_mfma_f32_32x32x16_bf16 v[80:95], v[148:151], a[184:187], v[80:95]
    ds_read_b64_tr_b16 v[140:141], v24 offset:2048
    ds_read_b64_tr_b16 v[142:143], v24 offset:2560
    s_waitcnt lgkmcnt(8)
    v_mfma_f32_32x32x16_bf16 v[64:79], v[152:155], a[188:191], v[64:79]
    ds_read_b64_tr_b16 v[144:145], v23 offset:4096
    ds_read_b64_tr_b16 v[146:147], v23 offset:4608
    v_mfma_f32_32x32x16_bf16 v[80:95], v[156:159], a[188:191], v[80:95]
    ds_read_b64_tr_b16 v[148:149], v24 offset:4096
    ds_read_b64_tr_b16 v[150:151], v24 offset:4608
    s_barrier
    s_waitcnt vmcnt(16)
    s_waitcnt lgkmcnt(8)
    v_mfma_f32_32x32x16_bf16 v[64:79], v[128:131], a[192:195], v[64:79]
    ds_read_b64_tr_b16 v[152:153], v23 offset:6144
    ds_read_b64_tr_b16 v[154:155], v23 offset:6656
    v_mfma_f32_32x32x16_bf16 v[80:95], v[132:135], a[192:195], v[80:95]
    ds_read_b64_tr_b16 v[156:157], v24 offset:6144
    ds_read_b64_tr_b16 v[158:159], v24 offset:6656
    s_lshl_b32 s33, s56, 1
    s_add_u32 s33, s33, 5
    s_cmp_ge_u32 s33, 7
    s_cselect_b32 s35, 7, 0
    s_sub_u32 s33, s33, s35
    s_add_u32 s33, s33, 1
    s_add_u32 s33, s33, s57
    s_and_b32 s33, s33, 7
    s_add_u32 m0, s31, 98304
    s_lshl_b32 s33, s33, 18
    s_lshl_b32 s34, s60, 7
    s_add_u32 s33, s33, s34
    buffer_load_dwordx4 v162, s[8:11], s33 offen  lds
    s_waitcnt lgkmcnt(8)
    v_mfma_f32_32x32x16_bf16 v[64:79], v[136:139], a[196:199], v[64:79]
    ds_read_b64_tr_b16 v[128:129], v23 offset:8192
    ds_read_b64_tr_b16 v[130:131], v23 offset:8704
    v_mfma_f32_32x32x16_bf16 v[80:95], v[140:143], a[196:199], v[80:95]
    ds_read_b64_tr_b16 v[132:133], v24 offset:8192
    ds_read_b64_tr_b16 v[134:135], v24 offset:8704
    buffer_load_dwordx4 v163, s[8:11], s33 offen offset:1024  lds
    s_waitcnt lgkmcnt(8)
    v_mfma_f32_32x32x16_bf16 v[64:79], v[144:147], a[200:203], v[64:79]
    ds_read_b64_tr_b16 v[136:137], v23 offset:10240
    ds_read_b64_tr_b16 v[138:139], v23 offset:10752
    v_mfma_f32_32x32x16_bf16 v[80:95], v[148:151], a[200:203], v[80:95]
    ds_read_b64_tr_b16 v[140:141], v24 offset:10240
    ds_read_b64_tr_b16 v[142:143], v24 offset:10752
    buffer_load_dwordx4 v164, s[8:11], s33 offen offset:2048  lds
    s_waitcnt lgkmcnt(8)
    v_mfma_f32_32x32x16_bf16 v[64:79], v[152:155], a[204:207], v[64:79]
    ds_read_b64_tr_b16 v[144:145], v23 offset:12288
    ds_read_b64_tr_b16 v[146:147], v23 offset:12800
    v_mfma_f32_32x32x16_bf16 v[80:95], v[156:159], a[204:207], v[80:95]
    ds_read_b64_tr_b16 v[148:149], v24 offset:12288
    ds_read_b64_tr_b16 v[150:151], v24 offset:12800
    buffer_load_dwordx4 v165, s[8:11], s33 offen offset:3072  lds
    s_waitcnt lgkmcnt(8)
    v_mfma_f32_32x32x16_bf16 v[64:79], v[128:131], a[208:211], v[64:79]
    ds_read_b64_tr_b16 v[152:153], v23 offset:14336
    ds_read_b64_tr_b16 v[154:155], v23 offset:14848
    v_mfma_f32_32x32x16_bf16 v[80:95], v[132:135], a[208:211], v[80:95]
    ds_read_b64_tr_b16 v[156:157], v24 offset:14336
    ds_read_b64_tr_b16 v[158:159], v24 offset:14848
    s_lshl_b32 s33, s56, 1
    s_add_u32 s33, s33, 6
    s_cmp_ge_u32 s33, 7
    s_cselect_b32 s35, 7, 0
    s_sub_u32 s33, s33, s35
    s_add_u32 s33, s33, 1
    s_add_u32 s33, s33, s57
    s_and_b32 s33, s33, 7
    s_add_u32 m0, s31, 114688
    s_lshl_b32 s33, s33, 18
    s_lshl_b32 s34, s60, 7
    s_add_u32 s33, s33, s34
    buffer_load_dwordx4 v162, s[8:11], s33 offen  lds
    s_waitcnt lgkmcnt(8)
    v_mfma_f32_32x32x16_bf16 v[64:79], v[136:139], a[212:215], v[64:79]
    ds_read_b64_tr_b16 v[128:129], v23 offset:16384
    ds_read_b64_tr_b16 v[130:131], v23 offset:16896
    v_mfma_f32_32x32x16_bf16 v[80:95], v[140:143], a[212:215], v[80:95]
    ds_read_b64_tr_b16 v[132:133], v24 offset:16384
    ds_read_b64_tr_b16 v[134:135], v24 offset:16896
    buffer_load_dwordx4 v163, s[8:11], s33 offen offset:1024  lds
    s_waitcnt lgkmcnt(8)
    v_mfma_f32_32x32x16_bf16 v[64:79], v[144:147], a[216:219], v[64:79]
    ds_read_b64_tr_b16 v[136:137], v23 offset:18432
    ds_read_b64_tr_b16 v[138:139], v23 offset:18944
    v_mfma_f32_32x32x16_bf16 v[80:95], v[148:151], a[216:219], v[80:95]
    ds_read_b64_tr_b16 v[140:141], v24 offset:18432
    ds_read_b64_tr_b16 v[142:143], v24 offset:18944
    buffer_load_dwordx4 v164, s[8:11], s33 offen offset:2048  lds
    s_waitcnt lgkmcnt(8)
    v_mfma_f32_32x32x16_bf16 v[64:79], v[152:155], a[220:223], v[64:79]
    ds_read_b64_tr_b16 v[144:145], v23 offset:20480
    ds_read_b64_tr_b16 v[146:147], v23 offset:20992
    v_mfma_f32_32x32x16_bf16 v[80:95], v[156:159], a[220:223], v[80:95]
    ds_read_b64_tr_b16 v[148:149], v24 offset:20480
    ds_read_b64_tr_b16 v[150:151], v24 offset:20992
    buffer_load_dwordx4 v165, s[8:11], s33 offen offset:3072  lds
    s_waitcnt vmcnt(16)
    s_waitcnt lgkmcnt(8)
    v_mfma_f32_32x32x16_bf16 v[64:79], v[128:131], a[224:227], v[64:79]
    ds_read_b64_tr_b16 v[152:153], v23 offset:22528
    ds_read_b64_tr_b16 v[154:155], v23 offset:23040
    v_mfma_f32_32x32x16_bf16 v[80:95], v[132:135], a[224:227], v[80:95]
    ds_read_b64_tr_b16 v[156:157], v24 offset:22528
    ds_read_b64_tr_b16 v[158:159], v24 offset:23040
    s_waitcnt lgkmcnt(8)
    v_mfma_f32_32x32x16_bf16 v[64:79], v[136:139], a[228:231], v[64:79]
    ds_read_b64_tr_b16 v[128:129], v23 offset:24576
    ds_read_b64_tr_b16 v[130:131], v23 offset:25088
    v_mfma_f32_32x32x16_bf16 v[80:95], v[140:143], a[228:231], v[80:95]
    ds_read_b64_tr_b16 v[132:133], v24 offset:24576
    ds_read_b64_tr_b16 v[134:135], v24 offset:25088
    s_waitcnt lgkmcnt(8)
    v_mfma_f32_32x32x16_bf16 v[64:79], v[144:147], a[232:235], v[64:79]
    ds_read_b64_tr_b16 v[136:137], v23 offset:26624
    ds_read_b64_tr_b16 v[138:139], v23 offset:27136
    v_mfma_f32_32x32x16_bf16 v[80:95], v[148:151], a[232:235], v[80:95]
    ds_read_b64_tr_b16 v[140:141], v24 offset:26624
    ds_read_b64_tr_b16 v[142:143], v24 offset:27136
    s_waitcnt lgkmcnt(8)
    v_mfma_f32_32x32x16_bf16 v[64:79], v[152:155], a[236:239], v[64:79]
    ds_read_b64_tr_b16 v[144:145], v23 offset:28672
    ds_read_b64_tr_b16 v[146:147], v23 offset:29184
    v_mfma_f32_32x32x16_bf16 v[80:95], v[156:159], a[236:239], v[80:95]
    ds_read_b64_tr_b16 v[148:149], v24 offset:28672
    ds_read_b64_tr_b16 v[150:151], v24 offset:29184
    s_waitcnt lgkmcnt(8)
    v_mfma_f32_32x32x16_bf16 v[64:79], v[128:131], a[240:243], v[64:79]
    ds_read_b64_tr_b16 v[152:153], v23 offset:30720
    ds_read_b64_tr_b16 v[154:155], v23 offset:31232
    v_mfma_f32_32x32x16_bf16 v[80:95], v[132:135], a[240:243], v[80:95]
    ds_read_b64_tr_b16 v[156:157], v24 offset:30720
    ds_read_b64_tr_b16 v[158:159], v24 offset:31232
    s_waitcnt lgkmcnt(8)
    v_mfma_f32_32x32x16_bf16 v[64:79], v[136:139], a[244:247], v[64:79]
    v_mfma_f32_32x32x16_bf16 v[80:95], v[140:143], a[244:247], v[80:95]
    s_waitcnt lgkmcnt(4)
    v_mfma_f32_32x32x16_bf16 v[64:79], v[144:147], a[248:251], v[64:79]
    v_mfma_f32_32x32x16_bf16 v[80:95], v[148:151], a[248:251], v[80:95]
    s_waitcnt lgkmcnt(0)
    v_mfma_f32_32x32x16_bf16 v[64:79], v[152:155], a[252:255], v[64:79]
    v_mfma_f32_32x32x16_bf16 v[80:95], v[156:159], a[252:255], v[80:95]
    s_lshl_b32 s35, s59, 1
    v_add_u32 v27, s35, v30
    v_lshlrev_b32 v27, 2, v27
    v_add_u32 v27, s58, v27
    v_lshlrev_b32 v27, 3, v27
    v_add_u32 v27, s61, v27
    v_mov_b32 v28, s96
    v_mov_b32 v29, s97
    s_xor_b32 s35, s58, 1
    s_lshl_b32 s35, s35, 2
    s_add_u32 s35, s35, s58
    s_lshl_b32 s35, s35, 3
    s_add_u32 s35, s35, s61
    v_mov_b32 v26, s35
    s_lshl_b32 s63, s58, 5
    s_add_u32 s55, s61, s63
    v_and_b32 v22, 3, v30
    v_lshlrev_b32 v22, 3, v22
    v_add_u32 v22, s55, v22
    s_waitcnt vmcnt(0)
    s_barrier
    ds_read_b64_tr_b16 v[128:129], v167 offset:0
    ds_read_b64_tr_b16 v[130:131], v167 offset:512
    ds_read_b64_tr_b16 v[132:133], v167 offset:2048
    ds_read_b64_tr_b16 v[134:135], v167 offset:2560
    ds_read_b64_tr_b16 v[136:137], v167 offset:4096
    ds_read_b64_tr_b16 v[138:139], v167 offset:4608
    ds_read_b64_tr_b16 v[140:141], v167 offset:6144
    ds_read_b64_tr_b16 v[142:143], v167 offset:6656
    ds_read_b64_tr_b16 v[144:145], v167 offset:8192
    ds_read_b64_tr_b16 v[146:147], v167 offset:8704
    ds_read_b64_tr_b16 v[148:149], v167 offset:10240
    ds_read_b64_tr_b16 v[150:151], v167 offset:10752
    s_waitcnt lgkmcnt(8)
    v_mfma_f32_32x32x16_bf16 v[96:111], v[128:131], a[32:35], v[96:111]
    ds_read_b64_tr_b16 v[152:153], v167 offset:12288
    ds_read_b64_tr_b16 v[154:155], v167 offset:12800
    v_mfma_f32_32x32x16_bf16 v[96:111], v[132:135], a[36:39], v[96:111]
    ds_read_b64_tr_b16 v[156:157], v167 offset:14336
    ds_read_b64_tr_b16 v[158:159], v167 offset:14848
    s_waitcnt lgkmcnt(8)
    v_mfma_f32_32x32x16_bf16 v[96:111], v[136:139], a[40:43], v[96:111]
    ds_read_b64_tr_b16 v[128:129], v168 offset:0
    ds_read_b64_tr_b16 v[130:131], v168 offset:512
    s_lshl_b32 s35, s59, 1
    s_lshl_b32 s32, s35, 4
    s_lshl_b32 s33, s58, 2
    s_add_u32 s32, s32, s33
    s_lshl_b32 s32, s32, 12
    buffer_store_dwordx4 v[64:67], v17, s[12:15], s32 offen sc1
    v_mfma_f32_32x32x16_bf16 v[96:111], v[140:143], a[44:47], v[96:111]
    ds_read_b64_tr_b16 v[132:133], v168 offset:2048
    ds_read_b64_tr_b16 v[134:135], v168 offset:2560
    buffer_store_dwordx4 v[68:71], v17, s[12:15], s32 offen offset:1024 sc1
    s_waitcnt lgkmcnt(8)
    v_mfma_f32_32x32x16_bf16 v[96:111], v[144:147], a[48:51], v[96:111]
    ds_read_b64_tr_b16 v[136:137], v168 offset:4096
    ds_read_b64_tr_b16 v[138:139], v168 offset:4608
    buffer_store_dwordx4 v[72:75], v17, s[12:15], s32 offen offset:2048 sc1
    v_mfma_f32_32x32x16_bf16 v[96:111], v[148:151], a[52:55], v[96:111]
    ds_read_b64_tr_b16 v[140:141], v168 offset:6144
    ds_read_b64_tr_b16 v[142:143], v168 offset:6656
    buffer_store_dwordx4 v[76:79], v17, s[12:15], s32 offen offset:3072 sc1
    s_waitcnt lgkmcnt(8)
    v_mfma_f32_32x32x16_bf16 v[96:111], v[152:155], a[56:59], v[96:111]
    ds_read_b64_tr_b16 v[144:145], v168 offset:8192
    ds_read_b64_tr_b16 v[146:147], v168 offset:8704
    s_lshl_b32 s35, s59, 1
    s_add_u32 s35, s35, 1
    s_lshl_b32 s32, s35, 4
    s_lshl_b32 s33, s58, 2
    s_add_u32 s32, s32, s33
    s_lshl_b32 s32, s32, 12
    buffer_store_dwordx4 v[80:83], v17, s[12:15], s32 offen sc1
    v_mfma_f32_32x32x16_bf16 v[96:111], v[156:159], a[60:63], v[96:111]
    ds_read_b64_tr_b16 v[148:149], v168 offset:10240
    ds_read_b64_tr_b16 v[150:151], v168 offset:10752
    buffer_store_dwordx4 v[84:87], v17, s[12:15], s32 offen offset:1024 sc1
    s_waitcnt lgkmcnt(8)
    v_mfma_f32_32x32x16_bf16 v[96:111], v[128:131], a[64:67], v[96:111]
    ds_read_b64_tr_b16 v[152:153], v168 offset:12288
    ds_read_b64_tr_b16 v[154:155], v168 offset:12800
    buffer_store_dwordx4 v[88:91], v17, s[12:15], s32 offen offset:2048 sc1
    v_mfma_f32_32x32x16_bf16 v[96:111], v[132:135], a[68:71], v[96:111]
    ds_read_b64_tr_b16 v[156:157], v168 offset:14336
    ds_read_b64_tr_b16 v[158:159], v168 offset:14848
    buffer_store_dwordx4 v[92:95], v17, s[12:15], s32 offen offset:3072 sc1
    s_waitcnt lgkmcnt(8)
    v_mfma_f32_32x32x16_bf16 v[96:111], v[136:139], a[72:75], v[96:111]
    ds_read_b64_tr_b16 v[128:129], v169 offset:0
    ds_read_b64_tr_b16 v[130:131], v169 offset:512
    v_mfma_f32_32x32x16_bf16 v[96:111], v[140:143], a[76:79], v[96:111]
    ds_read_b64_tr_b16 v[132:133], v169 offset:2048
    ds_read_b64_tr_b16 v[134:135], v169 offset:2560
    v_xor_b32 v167, 64, v167
    s_waitcnt lgkmcnt(8)
    v_mfma_f32_32x32x16_bf16 v[96:111], v[144:147], a[80:83], v[96:111]
    ds_read_b64_tr_b16 v[136:137], v169 offset:4096
    ds_read_b64_tr_b16 v[138:139], v169 offset:4608
    v_mfma_f32_32x32x16_bf16 v[96:111], v[148:151], a[84:87], v[96:111]
    ds_read_b64_tr_b16 v[140:141], v169 offset:6144
    ds_read_b64_tr_b16 v[142:143], v169 offset:6656
    s_waitcnt lgkmcnt(8)
    v_mfma_f32_32x32x16_bf16 v[96:111], v[152:155], a[88:91], v[96:111]
    ds_read_b64_tr_b16 v[144:145], v169 offset:8192
    ds_read_b64_tr_b16 v[146:147], v169 offset:8704
    v_mfma_f32_32x32x16_bf16 v[96:111], v[156:159], a[92:95], v[96:111]
    ds_read_b64_tr_b16 v[148:149], v169 offset:10240
    ds_read_b64_tr_b16 v[150:151], v169 offset:10752
    s_waitcnt lgkmcnt(8)
    v_mfma_f32_32x32x16_bf16 v[96:111], v[128:131], a[96:99], v[96:111]
    ds_read_b64_tr_b16 v[152:153], v169 offset:12288
    ds_read_b64_tr_b16 v[154:155], v169 offset:12800
    v_mfma_f32_32x32x16_bf16 v[96:111], v[132:135], a[100:103], v[96:111]
    ds_read_b64_tr_b16 v[156:157], v169 offset:14336
    ds_read_b64_tr_b16 v[158:159], v169 offset:14848
    s_waitcnt lgkmcnt(8)
    v_mfma_f32_32x32x16_bf16 v[96:111], v[136:139], a[104:107], v[96:111]
    ds_read_b64_tr_b16 v[128:129], v170 offset:0
    ds_read_b64_tr_b16 v[130:131], v170 offset:512
    v_mfma_f32_32x32x16_bf16 v[96:111], v[140:143], a[108:111], v[96:111]
    ds_read_b64_tr_b16 v[132:133], v170 offset:2048
    ds_read_b64_tr_b16 v[134:135], v170 offset:2560
    v_xor_b32 v168, 64, v168
    s_waitcnt lgkmcnt(8)
    v_mfma_f32_32x32x16_bf16 v[96:111], v[144:147], a[112:115], v[96:111]
    ds_read_b64_tr_b16 v[136:137], v170 offset:4096
    ds_read_b64_tr_b16 v[138:139], v170 offset:4608
    v_mfma_f32_32x32x16_bf16 v[96:111], v[148:151], a[116:119], v[96:111]
    ds_read_b64_tr_b16 v[140:141], v170 offset:6144
    ds_read_b64_tr_b16 v[142:143], v170 offset:6656
    s_waitcnt lgkmcnt(8)
    v_mfma_f32_32x32x16_bf16 v[96:111], v[152:155], a[120:123], v[96:111]
    ds_read_b64_tr_b16 v[144:145], v170 offset:8192
    ds_read_b64_tr_b16 v[146:147], v170 offset:8704
    v_mfma_f32_32x32x16_bf16 v[96:111], v[156:159], a[124:127], v[96:111]
    ds_read_b64_tr_b16 v[148:149], v170 offset:10240
    ds_read_b64_tr_b16 v[150:151], v170 offset:10752
    s_waitcnt lgkmcnt(8)
    v_mfma_f32_32x32x16_bf16 v[96:111], v[128:131], a[128:131], v[96:111]
    ds_read_b64_tr_b16 v[152:153], v170 offset:12288
    ds_read_b64_tr_b16 v[154:155], v170 offset:12800
    v_mfma_f32_32x32x16_bf16 v[96:111], v[132:135], a[132:135], v[96:111]
    ds_read_b64_tr_b16 v[156:157], v170 offset:14336
    ds_read_b64_tr_b16 v[158:159], v170 offset:14848
    s_waitcnt lgkmcnt(8)
    v_mfma_f32_32x32x16_bf16 v[96:111], v[136:139], a[136:139], v[96:111]
    ds_read_b64_tr_b16 v[128:129], v171 offset:0
    ds_read_b64_tr_b16 v[130:131], v171 offset:512
    v_mfma_f32_32x32x16_bf16 v[96:111], v[140:143], a[140:143], v[96:111]
    ds_read_b64_tr_b16 v[132:133], v171 offset:2048
    ds_read_b64_tr_b16 v[134:135], v171 offset:2560
    v_xor_b32 v169, 64, v169
    s_waitcnt lgkmcnt(8)
    v_mfma_f32_32x32x16_bf16 v[96:111], v[144:147], a[144:147], v[96:111]
    ds_read_b64_tr_b16 v[136:137], v171 offset:4096
    ds_read_b64_tr_b16 v[138:139], v171 offset:4608
    v_mfma_f32_32x32x16_bf16 v[96:111], v[148:151], a[148:151], v[96:111]
    ds_read_b64_tr_b16 v[140:141], v171 offset:6144
    ds_read_b64_tr_b16 v[142:143], v171 offset:6656
    s_waitcnt lgkmcnt(8)
    v_mfma_f32_32x32x16_bf16 v[96:111], v[152:155], a[152:155], v[96:111]
    ds_read_b64_tr_b16 v[144:145], v171 offset:8192
    ds_read_b64_tr_b16 v[146:147], v171 offset:8704
    v_mfma_f32_32x32x16_bf16 v[96:111], v[156:159], a[156:159], v[96:111]
    ds_read_b64_tr_b16 v[148:149], v171 offset:10240
    ds_read_b64_tr_b16 v[150:151], v171 offset:10752
    s_waitcnt lgkmcnt(8)
    v_mfma_f32_32x32x16_bf16 v[96:111], v[128:131], a[160:163], v[96:111]
    ds_read_b64_tr_b16 v[152:153], v171 offset:12288
    ds_read_b64_tr_b16 v[154:155], v171 offset:12800
    v_mfma_f32_32x32x16_bf16 v[96:111], v[132:135], a[164:167], v[96:111]
    ds_read_b64_tr_b16 v[156:157], v171 offset:14336
    ds_read_b64_tr_b16 v[158:159], v171 offset:14848
    s_waitcnt lgkmcnt(8)
    v_mfma_f32_32x32x16_bf16 v[96:111], v[136:139], a[168:171], v[96:111]
    ds_read_b64_tr_b16 v[128:129], v172 offset:0
    ds_read_b64_tr_b16 v[130:131], v172 offset:512
    s_waitcnt vmcnt(0)
    s_barrier
    s_cmp_lg_u32 s24, 0
    s_cbranch_scc1 L_nofA
    s_mov_b64 s[46:47], exec
    s_mov_b64 exec, 3
    global_store_dwordx2 v27, v[28:29], s[94:95] sc1
    s_mov_b64 exec, s[46:47]
L_nofA:
    s_nop 3
    v_mfma_f32_32x32x16_bf16 v[96:111], v[140:143], a[172:175], v[96:111]
    ds_read_b64_tr_b16 v[132:133], v172 offset:2048
    ds_read_b64_tr_b16 v[134:135], v172 offset:2560
    v_xor_b32 v170, 64, v170
    s_waitcnt lgkmcnt(8)
    v_mfma_f32_32x32x16_bf16 v[96:111], v[144:147], a[176:179], v[96:111]
    ds_read_b64_tr_b16 v[136:137], v172 offset:4096
    ds_read_b64_tr_b16 v[138:139], v172 offset:4608
    v_mfma_f32_32x32x16_bf16 v[96:111], v[148:151], a[180:183], v[96:111]
    ds_read_b64_tr_b16 v[140:141], v172 offset:6144
    ds_read_b64_tr_b16 v[142:143], v172 offset:6656
    s_waitcnt lgkmcnt(8)
    v_mfma_f32_32x32x16_bf16 v[96:111], v[152:155], a[184:187], v[96:111]
    ds_read_b64_tr_b16 v[144:145], v172 offset:8192
    ds_read_b64_tr_b16 v[146:147], v172 offset:8704
    v_mfma_f32_32x32x16_bf16 v[96:111], v[156:159], a[188:191], v[96:111]
    ds_read_b64_tr_b16 v[148:149], v172 offset:10240
    ds_read_b64_tr_b16 v[150:151], v172 offset:10752
    s_waitcnt lgkmcnt(8)
    v_mfma_f32_32x32x16_bf16 v[96:111], v[128:131], a[192:195], v[96:111]
    ds_read_b64_tr_b16 v[152:153], v172 offset:12288
    ds_read_b64_tr_b16 v[154:155], v172 offset:12800
    v_mfma_f32_32x32x16_bf16 v[96:111], v[132:135], a[196:199], v[96:111]
    ds_read_b64_tr_b16 v[156:157], v172 offset:14336
    ds_read_b64_tr_b16 v[158:159], v172 offset:14848
    s_waitcnt lgkmcnt(8)
    v_mfma_f32_32x32x16_bf16 v[96:111], v[136:139], a[200:203], v[96:111]
    ds_read_b64_tr_b16 v[128:129], v173 offset:0
    ds_read_b64_tr_b16 v[130:131], v173 offset:512
    v_mfma_f32_32x32x16_bf16 v[96:111], v[140:143], a[204:207], v[96:111]
    ds_read_b64_tr_b16 v[132:133], v173 offset:2048
    ds_read_b64_tr_b16 v[134:135], v173 offset:2560
    v_xor_b32 v171, 64, v171
    s_waitcnt lgkmcnt(8)
    v_mfma_f32_32x32x16_bf16 v[96:111], v[144:147], a[208:211], v[96:111]
    ds_read_b64_tr_b16 v[136:137], v173 offset:4096
    ds_read_b64_tr_b16 v[138:139], v173 offset:4608
    v_mfma_f32_32x32x16_bf16 v[96:111], v[148:151], a[212:215], v[96:111]
    ds_read_b64_tr_b16 v[140:141], v173 offset:6144
    ds_read_b64_tr_b16 v[142:143], v173 offset:6656
    s_waitcnt lgkmcnt(8)
    v_mfma_f32_32x32x16_bf16 v[96:111], v[152:155], a[216:219], v[96:111]
    ds_read_b64_tr_b16 v[144:145], v173 offset:8192
    ds_read_b64_tr_b16 v[146:147], v173 offset:8704
    v_mfma_f32_32x32x16_bf16 v[96:111], v[156:159], a[220:223], v[96:111]
    ds_read_b64_tr_b16 v[148:149], v173 offset:10240
    ds_read_b64_tr_b16 v[150:151], v173 offset:10752
    s_waitcnt lgkmcnt(8)
    v_mfma_f32_32x32x16_bf16 v[96:111], v[128:131], a[224:227], v[96:111]
    ds_read_b64_tr_b16 v[152:153], v173 offset:12288
    ds_read_b64_tr_b16 v[154:155], v173 offset:12800
    v_mfma_f32_32x32x16_bf16 v[96:111], v[132:135], a[228:231], v[96:111]
    ds_read_b64_tr_b16 v[156:157], v173 offset:14336
    ds_read_b64_tr_b16 v[158:159], v173 offset:14848
    s_waitcnt lgkmcnt(8)
    v_mfma_f32_32x32x16_bf16 v[96:111], v[136:139], a[232:235], v[96:111]
    ds_read_b64_tr_b16 v[128:129], v167 offset:0
    ds_read_b64_tr_b16 v[130:131], v167 offset:512
    v_mfma_f32_32x32x16_bf16 v[96:111], v[140:143], a[236:239], v[96:111]
    ds_read_b64_tr_b16 v[132:133], v167 offset:2048
    ds_read_b64_tr_b16 v[134:135], v167 offset:2560
    v_xor_b32 v172, 64, v172
    v_xor_b32 v173, 64, v173
    s_waitcnt lgkmcnt(8)
    v_mfma_f32_32x32x16_bf16 v[96:111], v[144:147], a[240:243], v[96:111]
    ds_read_b64_tr_b16 v[136:137], v167 offset:4096
    ds_read_b64_tr_b16 v[138:139], v167 offset:4608
    v_mfma_f32_32x32x16_bf16 v[96:111], v[148:151], a[244:247], v[96:111]
    ds_read_b64_tr_b16 v[140:141], v167 offset:6144
    ds_read_b64_tr_b16 v[142:143], v167 offset:6656
    s_waitcnt lgkmcnt(8)
    v_mfma_f32_32x32x16_bf16 v[96:111], v[152:155], a[248:251], v[96:111]
    ds_read_b64_tr_b16 v[144:145], v167 offset:8192
    ds_read_b64_tr_b16 v[146:147], v167 offset:8704
    v_mfma_f32_32x32x16_bf16 v[96:111], v[156:159], a[252:255], v[96:111]
    ds_read_b64_tr_b16 v[148:149], v167 offset:10240
    ds_read_b64_tr_b16 v[150:151], v167 offset:10752
    s_waitcnt lgkmcnt(8)
    v_mfma_f32_32x32x16_bf16 v[112:127], v[128:131], a[32:35], v[112:127]
    ds_read_b64_tr_b16 v[152:153], v167 offset:12288
    ds_read_b64_tr_b16 v[154:155], v167 offset:12800
    v_mfma_f32_32x32x16_bf16 v[112:127], v[132:135], a[36:39], v[112:127]
    ds_read_b64_tr_b16 v[156:157], v167 offset:14336
    ds_read_b64_tr_b16 v[158:159], v167 offset:14848
    s_waitcnt lgkmcnt(8)
    v_mfma_f32_32x32x16_bf16 v[112:127], v[136:139], a[40:43], v[112:127]
    ds_read_b64_tr_b16 v[128:129], v168 offset:0
    ds_read_b64_tr_b16 v[130:131], v168 offset:512
    v_mfma_f32_32x32x16_bf16 v[112:127], v[140:143], a[44:47], v[112:127]
    ds_read_b64_tr_b16 v[132:133], v168 offset:2048
    ds_read_b64_tr_b16 v[134:135], v168 offset:2560
    s_waitcnt lgkmcnt(8)
    v_mfma_f32_32x32x16_bf16 v[112:127], v[144:147], a[48:51], v[112:127]
    ds_read_b64_tr_b16 v[136:137], v168 offset:4096
    ds_read_b64_tr_b16 v[138:139], v168 offset:4608
    s_xor_b32 s35, s58, 1
    s_lshl_b32 s32, s35, 4
    s_lshl_b32 s33, s58, 2
    s_add_u32 s32, s32, s33
    s_lshl_b32 s32, s32, 12
    buffer_store_dwordx4 v[96:99], v17, s[12:15], s32 offen sc1
    v_mfma_f32_32x32x16_bf16 v[112:127], v[148:151], a[52:55], v[112:127]
    ds_read_b64_tr_b16 v[140:141], v168 offset:6144
    ds_read_b64_tr_b16 v[142:143], v168 offset:6656
    buffer_store_dwordx4 v[100:103], v17, s[12:15], s32 offen offset:1024 sc1
    s_waitcnt lgkmcnt(8)
    v_mfma_f32_32x32x16_bf16 v[112:127], v[152:155], a[56:59], v[112:127]
    ds_read_b64_tr_b16 v[144:145], v168 offset:8192
    ds_read_b64_tr_b16 v[146:147], v168 offset:8704
    buffer_store_dwordx4 v[104:107], v17, s[12:15], s32 offen offset:2048 sc1
    v_mfma_f32_32x32x16_bf16 v[112:127], v[156:159], a[60:63], v[112:127]
    ds_read_b64_tr_b16 v[148:149], v168 offset:10240
    ds_read_b64_tr_b16 v[150:151], v168 offset:10752
    buffer_store_dwordx4 v[108:111], v17, s[12:15], s32 offen offset:3072 sc1
    s_waitcnt lgkmcnt(8)
    v_mfma_f32_32x32x16_bf16 v[112:127], v[128:131], a[64:67], v[112:127]
    ds_read_b64_tr_b16 v[152:153], v168 offset:12288
    ds_read_b64_tr_b16 v[154:155], v168 offset:12800
    v_mfma_f32_32x32x16_bf16 v[112:127], v[132:135], a[68:71], v[112:127]
    ds_read_b64_tr_b16 v[156:157], v168 offset:14336
    ds_read_b64_tr_b16 v[158:159], v168 offset:14848
    s_waitcnt lgkmcnt(8)
    v_mfma_f32_32x32x16_bf16 v[112:127], v[136:139], a[72:75], v[112:127]
    ds_read_b64_tr_b16 v[128:129], v169 offset:0
    ds_read_b64_tr_b16 v[130:131], v169 offset:512
    v_mfma_f32_32x32x16_bf16 v[112:127], v[140:143], a[76:79], v[112:127]
    ds_read_b64_tr_b16 v[132:133], v169 offset:2048
    ds_read_b64_tr_b16 v[134:135], v169 offset:2560
    s_waitcnt lgkmcnt(8)
    v_mfma_f32_32x32x16_bf16 v[112:127], v[144:147], a[80:83], v[112:127]
    ds_read_b64_tr_b16 v[136:137], v169 offset:4096
    ds_read_b64_tr_b16 v[138:139], v169 offset:4608
    global_load_dwordx2 v[20:21], v22, s[94:95] sc1
    v_mfma_f32_32x32x16_bf16 v[112:127], v[148:151], a[84:87], v[112:127]
    ds_read_b64_tr_b16 v[140:141], v169 offset:6144
    ds_read_b64_tr_b16 v[142:143], v169 offset:6656
    s_waitcnt lgkmcnt(8)
    v_mfma_f32_32x32x16_bf16 v[112:127], v[152:155], a[88:91], v[112:127]
    ds_read_b64_tr_b16 v[144:145], v169 offset:8192
    ds_read_b64_tr_b16 v[146:147], v169 offset:8704
    v_mfma_f32_32x32x16_bf16 v[112:127], v[156:159], a[92:95], v[112:127]
    ds_read_b64_tr_b16 v[148:149], v169 offset:10240
    ds_read_b64_tr_b16 v[150:151], v169 offset:10752
    s_waitcnt lgkmcnt(8)
    v_mfma_f32_32x32x16_bf16 v[112:127], v[128:131], a[96:99], v[112:127]
    ds_read_b64_tr_b16 v[152:153], v169 offset:12288
    ds_read_b64_tr_b16 v[154:155], v169 offset:12800
    v_mfma_f32_32x32x16_bf16 v[112:127], v[132:135], a[100:103], v[112:127]
    ds_read_b64_tr_b16 v[156:157], v169 offset:14336
    ds_read_b64_tr_b16 v[158:159], v169 offset:14848
    s_waitcnt lgkmcnt(8)
    v_mfma_f32_32x32x16_bf16 v[112:127], v[136:139], a[104:107], v[112:127]
    ds_read_b64_tr_b16 v[128:129], v170 offset:0
    ds_read_b64_tr_b16 v[130:131], v170 offset:512
    v_mfma_f32_32x32x16_bf16 v[112:127], v[140:143], a[108:111], v[112:127]
    ds_read_b64_tr_b16 v[132:133], v170 offset:2048
    ds_read_b64_tr_b16 v[134:135], v170 offset:2560
    s_waitcnt lgkmcnt(8)
    v_mfma_f32_32x32x16_bf16 v[112:127], v[144:147], a[112:115], v[112:127]
    ds_read_b64_tr_b16 v[136:137], v170 offset:4096
    ds_read_b64_tr_b16 v[138:139], v170 offset:4608
    v_mfma_f32_32x32x16_bf16 v[112:127], v[148:151], a[116:119], v[112:127]
    ds_read_b64_tr_b16 v[140:141], v170 offset:6144
    ds_read_b64_tr_b16 v[142:143], v170 offset:6656
    s_waitcnt lgkmcnt(8)
    v_mfma_f32_32x32x16_bf16 v[112:127], v[152:155], a[120:123], v[112:127]
    ds_read_b64_tr_b16 v[144:145], v170 offset:8192
    ds_read_b64_tr_b16 v[146:147], v170 offset:8704
    v_mfma_f32_32x32x16_bf16 v[112:127], v[156:159], a[124:127], v[112:127]
    ds_read_b64_tr_b16 v[148:149], v170 offset:10240
    ds_read_b64_tr_b16 v[150:151], v170 offset:10752
    s_waitcnt lgkmcnt(8)
    v_mfma_f32_32x32x16_bf16 v[112:127], v[128:131], a[128:131], v[112:127]
    ds_read_b64_tr_b16 v[152:153], v170 offset:12288
    ds_read_b64_tr_b16 v[154:155], v170 offset:12800
    v_mfma_f32_32x32x16_bf16 v[112:127], v[132:135], a[132:135], v[112:127]
    ds_read_b64_tr_b16 v[156:157], v170 offset:14336
    ds_read_b64_tr_b16 v[158:159], v170 offset:14848
    s_waitcnt lgkmcnt(8)
    v_mfma_f32_32x32x16_bf16 v[112:127], v[136:139], a[136:139], v[112:127]
    ds_read_b64_tr_b16 v[128:129], v171 offset:0
    ds_read_b64_tr_b16 v[130:131], v171 offset:512
    v_mfma_f32_32x32x16_bf16 v[112:127], v[140:143], a[140:143], v[112:127]
    ds_read_b64_tr_b16 v[132:133], v171 offset:2048
    ds_read_b64_tr_b16 v[134:135], v171 offset:2560
    s_waitcnt lgkmcnt(8)
    v_mfma_f32_32x32x16_bf16 v[112:127], v[144:147], a[144:147], v[112:127]
    ds_read_b64_tr_b16 v[136:137], v171 offset:4096
    ds_read_b64_tr_b16 v[138:139], v171 offset:4608
    v_mfma_f32_32x32x16_bf16 v[112:127], v[148:151], a[148:151], v[112:127]
    ds_read_b64_tr_b16 v[140:141], v171 offset:6144
    ds_read_b64_tr_b16 v[142:143], v171 offset:6656
    s_waitcnt lgkmcnt(8)
    v_mfma_f32_32x32x16_bf16 v[112:127], v[152:155], a[152:155], v[112:127]
    ds_read_b64_tr_b16 v[144:145], v171 offset:8192
    ds_read_b64_tr_b16 v[146:147], v171 offset:8704
    v_mfma_f32_32x32x16_bf16 v[112:127], v[156:159], a[156:159], v[112:127]
    ds_read_b64_tr_b16 v[148:149], v171 offset:10240
    ds_read_b64_tr_b16 v[150:151], v171 offset:10752
    s_waitcnt lgkmcnt(8)
    v_mfma_f32_32x32x16_bf16 v[112:127], v[128:131], a[160:163], v[112:127]
    ds_read_b64_tr_b16 v[152:153], v171 offset:12288
    ds_read_b64_tr_b16 v[154:155], v171 offset:12800
    v_mfma_f32_32x32x16_bf16 v[112:127], v[132:135], a[164:167], v[112:127]
    ds_read_b64_tr_b16 v[156:157], v171 offset:14336
    ds_read_b64_tr_b16 v[158:159], v171 offset:14848
    s_waitcnt lgkmcnt(8)
    v_mfma_f32_32x32x16_bf16 v[112:127], v[136:139], a[168:171], v[112:127]
    ds_read_b64_tr_b16 v[128:129], v172 offset:0
    ds_read_b64_tr_b16 v[130:131], v172 offset:512
    s_waitcnt vmcnt(0)
    s_barrier
    s_cmp_lg_u32 s24, 0
    s_cbranch_scc1 L_nofB
    s_mov_b64 s[46:47], exec
    s_mov_b64 exec, 1
    global_store_dwordx2 v26, v[28:29], s[94:95] sc1
    s_mov_b64 exec, s[46:47]
L_nofB:
    s_xor_b32 s33, s58, 2
    s_lshl_b32 s48, 1, s33
    s_xor_b32 s33, s58, 3
    s_lshl_b32 s34, 1, s33
    s_or_b32 s48, s48, s34
    s_mov_b32 s49, 0
    v_cmp_eq_u32 vcc, s96, v20
    v_cmp_eq_u32 s[50:51], s97, v21
    s_nop 3
    s_and_b64 s[50:51], s[50:51], vcc
    s_and_b32 s50, s50, s48
    s_cmp_eq_u32 s50, s48
    s_cbranch_scc0 L_noearly
    s_xor_b32 s33, s58, 2
    s_lshl_b32 s33, s33, 2
    s_lshl_b32 s32, s58, 4
    s_add_u32 s32, s32, s33
    s_lshl_b32 s32, s32, 12
    buffer_load_dwordx4 v[208:211], v17, s[12:15], s32 offen offset:0 sc1
    buffer_load_dwordx4 v[212:215], v17, s[12:15], s32 offen offset:1024 sc1
    buffer_load_dwordx4 v[216:219], v17, s[12:15], s32 offen offset:2048 sc1
    buffer_load_dwordx4 v[220:223], v17, s[12:15], s32 offen offset:3072 sc1
    s_xor_b32 s33, s58, 3
    s_lshl_b32 s33, s33, 2
    s_lshl_b32 s32, s58, 4
    s_add_u32 s32, s32, s33
    s_lshl_b32 s32, s32, 12
    buffer_load_dwordx4 v[224:227], v17, s[12:15], s32 offen offset:0 sc1
    buffer_load_dwordx4 v[228:231], v17, s[12:15], s32 offen offset:1024 sc1
    buffer_load_dwordx4 v[232:235], v17, s[12:15], s32 offen offset:2048 sc1
    buffer_load_dwordx4 v[236:239], v17, s[12:15], s32 offen offset:3072 sc1
    s_mov_b32 s49, 1
L_noearly:
    v_mfma_f32_32x32x16_bf16 v[112:127], v[140:143], a[172:175], v[112:127]
    ds_read_b64_tr_b16 v[132:133], v172 offset:2048
    ds_read_b64_tr_b16 v[134:135], v172 offset:2560
    s_waitcnt lgkmcnt(8)
    v_mfma_f32_32x32x16_bf16 v[112:127], v[144:147], a[176:179], v[112:127]
    ds_read_b64_tr_b16 v[136:137], v172 offset:4096
    ds_read_b64_tr_b16 v[138:139], v172 offset:4608
    v_mfma_f32_32x32x16_bf16 v[112:127], v[148:151], a[180:183], v[112:127]
    ds_read_b64_tr_b16 v[140:141], v172 offset:6144
    ds_read_b64_tr_b16 v[142:143], v172 offset:6656
    s_waitcnt lgkmcnt(8)
    v_mfma_f32_32x32x16_bf16 v[112:127], v[152:155], a[184:187], v[112:127]
    ds_read_b64_tr_b16 v[144:145], v172 offset:8192
    ds_read_b64_tr_b16 v[146:147], v172 offset:8704
    v_mfma_f32_32x32x16_bf16 v[112:127], v[156:159], a[188:191], v[112:127]
    ds_read_b64_tr_b16 v[148:149], v172 offset:10240
    ds_read_b64_tr_b16 v[150:151], v172 offset:10752
    s_waitcnt lgkmcnt(8)
    v_mfma_f32_32x32x16_bf16 v[112:127], v[128:131], a[192:195], v[112:127]
    ds_read_b64_tr_b16 v[152:153], v172 offset:12288
    ds_read_b64_tr_b16 v[154:155], v172 offset:12800
    v_mfma_f32_32x32x16_bf16 v[112:127], v[132:135], a[196:199], v[112:127]
    ds_read_b64_tr_b16 v[156:157], v172 offset:14336
    ds_read_b64_tr_b16 v[158:159], v172 offset:14848
    s_waitcnt lgkmcnt(8)
    v_mfma_f32_32x32x16_bf16 v[112:127], v[136:139], a[200:203], v[112:127]
    ds_read_b64_tr_b16 v[128:129], v173 offset:0
    ds_read_b64_tr_b16 v[130:131], v173 offset:512
    v_mfma_f32_32x32x16_bf16 v[112:127], v[140:143], a[204:207], v[112:127]
    ds_read_b64_tr_b16 v[132:133], v173 offset:2048
    ds_read_b64_tr_b16 v[134:135], v173 offset:2560
    s_waitcnt lgkmcnt(8)
    v_mfma_f32_32x32x16_bf16 v[112:127], v[144:147], a[208:211], v[112:127]
    ds_read_b64_tr_b16 v[136:137], v173 offset:4096
    ds_read_b64_tr_b16 v[138:139], v173 offset:4608
    v_mfma_f32_32x32x16_bf16 v[112:127], v[148:151], a[212:215], v[112:127]
    ds_read_b64_tr_b16 v[140:141], v173 offset:6144
    ds_read_b64_tr_b16 v[142:143], v173 offset:6656
    s_waitcnt lgkmcnt(8)
    v_mfma_f32_32x32x16_bf16 v[112:127], v[152:155], a[216:219], v[112:127]
    ds_read_b64_tr_b16 v[144:145], v173 offset:8192
    ds_read_b64_tr_b16 v[146:147], v173 offset:8704
    v_mfma_f32_32x32x16_bf16 v[112:127], v[156:159], a[220:223], v[112:127]
    ds_read_b64_tr_b16 v[148:149], v173 offset:10240
    ds_read_b64_tr_b16 v[150:151], v173 offset:10752
    s_waitcnt lgkmcnt(8)
    v_mfma_f32_32x32x16_bf16 v[112:127], v[128:131], a[224:227], v[112:127]
    ds_read_b64_tr_b16 v[152:153], v173 offset:12288
    ds_read_b64_tr_b16 v[154:155], v173 offset:12800
    v_mfma_f32_32x32x16_bf16 v[112:127], v[132:135], a[228:231], v[112:127]
    ds_read_b64_tr_b16 v[156:157], v173 offset:14336
    ds_read_b64_tr_b16 v[158:159], v173 offset:14848
    s_waitcnt lgkmcnt(8)
    v_mfma_f32_32x32x16_bf16 v[112:127], v[136:139], a[232:235], v[112:127]
    global_load_dwordx2 v[20:21], v22, s[94:95] sc1
    v_mfma_f32_32x32x16_bf16 v[112:127], v[140:143], a[236:239], v[112:127]
    s_waitcnt lgkmcnt(4)
    v_mfma_f32_32x32x16_bf16 v[112:127], v[144:147], a[240:243], v[112:127]
    v_mfma_f32_32x32x16_bf16 v[112:127], v[148:151], a[244:247], v[112:127]
    s_waitcnt lgkmcnt(0)
    v_mfma_f32_32x32x16_bf16 v[112:127], v[152:155], a[248:251], v[112:127]
    v_mfma_f32_32x32x16_bf16 v[112:127], v[156:159], a[252:255], v[112:127]
    s_lshl_b32 s48, 1, s58
    s_xor_b32 s48, s48, 15
    s_mov_b32 s63, 0
L_poll2:
    s_waitcnt vmcnt(0)
    v_cmp_eq_u32 vcc, s96, v20
    v_cmp_eq_u32 s[50:51], s97, v21
    s_nop 3
    s_and_b64 s[50:51], s[50:51], vcc
    s_and_b32 s50, s50, s48
    s_cmp_eq_u32 s50, s48
    s_cbranch_scc1 L_poll2_ok
    s_add_u32 s63, s63, 1
    s_cmp_gt_u32 s63, 262144
    s_cbranch_scc1 L_poll2_ok
    global_load_dwordx2 v[20:21], v22, s[94:95] sc1
    s_branch L_poll2
L_poll2_ok:
    s_cmp_lg_u32 s49, 0
    s_cbranch_scc1 L_haveearly
    s_xor_b32 s33, s58, 2
    s_lshl_b32 s33, s33, 2
    s_lshl_b32 s32, s58, 4
    s_add_u32 s32, s32, s33
    s_lshl_b32 s32, s32, 12
    buffer_load_dwordx4 v[208:211], v17, s[12:15], s32 offen offset:0 sc1
    buffer_load_dwordx4 v[212:215], v17, s[12:15], s32 offen offset:1024 sc1
    buffer_load_dwordx4 v[216:219], v17, s[12:15], s32 offen offset:2048 sc1
    buffer_load_dwordx4 v[220:223], v17, s[12:15], s32 offen offset:3072 sc1
    s_xor_b32 s33, s58, 3
    s_lshl_b32 s33, s33, 2
    s_lshl_b32 s32, s58, 4
    s_add_u32 s32, s32, s33
    s_lshl_b32 s32, s32, 12
    buffer_load_dwordx4 v[224:227], v17, s[12:15], s32 offen offset:0 sc1
    buffer_load_dwordx4 v[228:231], v17, s[12:15], s32 offen offset:1024 sc1
    buffer_load_dwordx4 v[232:235], v17, s[12:15], s32 offen offset:2048 sc1
    buffer_load_dwordx4 v[236:239], v17, s[12:15], s32 offen offset:3072 sc1
L_haveearly:
    s_xor_b32 s33, s58, 1
    s_lshl_b32 s33, s33, 2
    s_lshl_b32 s32, s58, 4
    s_add_u32 s32, s32, s33
    s_lshl_b32 s32, s32, 12
    buffer_load_dwordx4 v[240:243], v17, s[12:15], s32 offen offset:0 sc1
    buffer_load_dwordx4 v[244:247], v17, s[12:15], s32 offen offset:1024 sc1
    buffer_load_dwordx4 v[248:251], v17, s[12:15], s32 offen offset:2048 sc1
    buffer_load_dwordx4 v[252:255], v17, s[12:15], s32 offen offset:3072 sc1
    v_and_b32 v2, 31, v30
    v_lshrrev_b32 v3, 5, v30
    s_lshl_b32 s46, s25, 7
    s_lshl_b32 s47, s24, 5
    s_add_u32 s46, s46, s47
    v_add_u32 v2, s46, v2
    v_lshlrev_b32 v2, 11, v2
    v_lshl_add_u32 v2, v3, 4, v2
    s_lshl_b32 s46, s57, 8
    s_lshl_b32 s47, s58, 6
    s_add_u32 s46, s46, s47
    v_add_u32 v2, s46, v2
    s_waitcnt vmcnt(4)
    v_add_f32 v112, v112, v208
    v_add_f32 v113, v113, v209
    v_add_f32 v114, v114, v210
    v_add_f32 v115, v115, v211
    v_add_f32 v116, v116, v212
    v_add_f32 v117, v117, v213
    v_add_f32 v118, v118, v214
    v_add_f32 v119, v119, v215
    v_add_f32 v120, v120, v216
    v_add_f32 v121, v121, v217
    v_add_f32 v122, v122, v218
    v_add_f32 v123, v123, v219
    v_add_f32 v124, v124, v220
    v_add_f32 v125, v125, v221
    v_add_f32 v126, v126, v222
    v_add_f32 v127, v127, v223
    v_add_f32 v112, v112, v224
    v_add_f32 v113, v113, v225
    v_add_f32 v114, v114, v226
    v_add_f32 v115, v115, v227
    v_add_f32 v116, v116, v228
    v_add_f32 v117, v117, v229
    v_add_f32 v118, v118, v230
    v_add_f32 v119, v119, v231
    v_add_f32 v120, v120, v232
    v_add_f32 v121, v121, v233
    v_add_f32 v122, v122, v234
    v_add_f32 v123, v123, v235
    v_add_f32 v124, v124, v236
    v_add_f32 v125, v125, v237
    v_add_f32 v126, v126, v238
    v_add_f32 v127, v127, v239
    s_waitcnt vmcnt(0)
    v_add_f32 v112, v112, v240
    v_add_f32 v113, v113, v241
    v_add_f32 v114, v114, v242
    v_add_f32 v115, v115, v243
    v_add_f32 v116, v116, v244
    v_add_f32 v117, v117, v245
    v_add_f32 v118, v118, v246
    v_add_f32 v119, v119, v247
    v_add_f32 v120, v120, v248
    v_add_f32 v121, v121, v249
    v_add_f32 v122, v122, v250
    v_add_f32 v123, v123, v251
    v_add_f32 v124, v124, v252
    v_add_f32 v125, v125, v253
    v_add_f32 v126, v126, v254
    v_add_f32 v127, v127, v255
    v_cvt_pk_bf16_f32 v8, v112, v113
    v_cvt_pk_bf16_f32 v9, v114, v115
    v_cvt_pk_bf16_f32 v10, v116, v117
    v_cvt_pk_bf16_f32 v11, v118, v119
    buffer_store_dwordx4 v[8:11], v2, s[16:19], 0 offen offset:0
    v_cvt_pk_bf16_f32 v12, v120, v121
    v_cvt_pk_bf16_f32 v13, v122, v123
    v_cvt_pk_bf16_f32 v14, v124, v125
    v_cvt_pk_bf16_f32 v15, v126, v127
    buffer_store_dwordx4 v[12:15], v2, s[16:19], 0 offen offset:32
L_end:
    s_endpgm
L_raise0:
    s_nop 7
    v_mov_b32 v6, v5
    v_nop
    v_nop
    v_permlane32_swap_b32 v5, v6
    v_max_f32 v5, v5, v6
    v_sub_f32 v64, v64, v5
    v_sub_f32 v65, v65, v5
    v_sub_f32 v66, v66, v5
    v_sub_f32 v67, v67, v5
    v_sub_f32 v68, v68, v5
    v_sub_f32 v69, v69, v5
    v_sub_f32 v70, v70, v5
    v_sub_f32 v71, v71, v5
    v_sub_f32 v72, v72, v5
    v_sub_f32 v73, v73, v5
    v_sub_f32 v74, v74, v5
    v_sub_f32 v75, v75, v5
    v_sub_f32 v76, v76, v5
    v_sub_f32 v77, v77, v5
    v_sub_f32 v78, v78, v5
    v_sub_f32 v79, v79, v5
    v_sub_f32 v80, v80, v5
    v_sub_f32 v81, v81, v5
    v_sub_f32 v82, v82, v5
    v_sub_f32 v83, v83, v5
    v_sub_f32 v84, v84, v5
    v_sub_f32 v85, v85, v5
    v_sub_f32 v86, v86, v5
    v_sub_f32 v87, v87, v5
    v_sub_f32 v88, v88, v5
    v_sub_f32 v89, v89, v5
    v_sub_f32 v90, v90, v5
    v_sub_f32 v91, v91, v5
    v_sub_f32 v92, v92, v5
    v_sub_f32 v93, v93, v5
    v_sub_f32 v94, v94, v5
    v_sub_f32 v95, v95, v5
    v_sub_f32 v96, v96, v5
    v_sub_f32 v97, v97, v5
    v_sub_f32 v98, v98, v5
    v_sub_f32 v99, v99, v5
    v_sub_f32 v100, v100, v5
    v_sub_f32 v101, v101, v5
    v_sub_f32 v102, v102, v5
    v_sub_f32 v103, v103, v5
    v_sub_f32 v104, v104, v5
    v_sub_f32 v105, v105, v5
    v_sub_f32 v106, v106, v5
    v_sub_f32 v107, v107, v5
    v_sub_f32 v108, v108, v5
    v_sub_f32 v109, v109, v5
    v_sub_f32 v110, v110, v5
    v_sub_f32 v111, v111, v5
    v_sub_f32 v112, v112, v5
    v_sub_f32 v113, v113, v5
    v_sub_f32 v114, v114, v5
    v_sub_f32 v115, v115, v5
    v_sub_f32 v116, v116, v5
    v_sub_f32 v117, v117, v5
    v_sub_f32 v118, v118, v5
    v_sub_f32 v119, v119, v5
    v_sub_f32 v120, v120, v5
    v_sub_f32 v121, v121, v5
    v_sub_f32 v122, v122, v5
    v_sub_f32 v123, v123, v5
    v_sub_f32 v124, v124, v5
    v_sub_f32 v125, v125, v5
    v_sub_f32 v126, v126, v5
    v_sub_f32 v127, v127, v5
    v_sub_f32 v176, v176, v5
    v_sub_f32 v177, v177, v5
    v_sub_f32 v178, v178, v5
    v_sub_f32 v179, v179, v5
    v_sub_f32 v180, v180, v5
    v_sub_f32 v181, v181, v5
    v_sub_f32 v182, v182, v5
    v_sub_f32 v183, v183, v5
    v_sub_f32 v184, v184, v5
    v_sub_f32 v185, v185, v5
    v_sub_f32 v186, v186, v5
    v_sub_f32 v187, v187, v5
    v_sub_f32 v188, v188, v5
    v_sub_f32 v189, v189, v5
    v_sub_f32 v190, v190, v5
    v_sub_f32 v191, v191, v5
    s_nop 7
    s_branch L_raise0_back
L_rs_a0:
    s_nop 15
    v_mul_f32 v192, v192, v3
    v_mul_f32 v193, v193, v3
    v_mul_f32 v194, v194, v3
    v_mul_f32 v195, v195, v3
    v_mul_f32 v196, v196, v3
    v_mul_f32 v197, v197, v3
    v_mul_f32 v198, v198, v3
    v_mul_f32 v199, v199, v3
    v_mul_f32 v200, v200, v3
    v_mul_f32 v201, v201, v3
    v_mul_f32 v202, v202, v3
    v_mul_f32 v203, v203, v3
    v_mul_f32 v204, v204, v3
    v_mul_f32 v205, v205, v3
    v_mul_f32 v206, v206, v3
    v_mul_f32 v207, v207, v3
    v_mul_f32 v208, v208, v3
    v_mul_f32 v209, v209, v3
    v_mul_f32 v210, v210, v3
    v_mul_f32 v211, v211, v3
    v_mul_f32 v212, v212, v3
    v_mul_f32 v213, v213, v3
    v_mul_f32 v214, v214, v3
    v_mul_f32 v215, v215, v3
    v_mul_f32 v216, v216, v3
    v_mul_f32 v217, v217, v3
    v_mul_f32 v218, v218, v3
    v_mul_f32 v219, v219, v3
    v_mul_f32 v220, v220, v3
    v_mul_f32 v221, v221, v3
    v_mul_f32 v222, v222, v3
    v_mul_f32 v223, v223, v3
    v_mul_f32 v224, v224, v3
    v_mul_f32 v225, v225, v3
    v_mul_f32 v226, v226, v3
    v_mul_f32 v227, v227, v3
    v_mul_f32 v228, v228, v3
    v_mul_f32 v229, v229, v3
    v_mul_f32 v230, v230, v3
    v_mul_f32 v231, v231, v3
    v_mul_f32 v232, v232, v3
    v_mul_f32 v233, v233, v3
    v_mul_f32 v234, v234, v3
    v_mul_f32 v235, v235, v3
    v_mul_f32 v236, v236, v3
    v_mul_f32 v237, v237, v3
    v_mul_f32 v238, v238, v3
    v_mul_f32 v239, v239, v3
    v_mul_f32 v240, v240, v3
    v_mul_f32 v241, v241, v3
    v_mul_f32 v242, v242, v3
    v_mul_f32 v243, v243, v3
    v_mul_f32 v244, v244, v3
    v_mul_f32 v245, v245, v3
    v_mul_f32 v246, v246, v3
    v_mul_f32 v247, v247, v3
    v_mul_f32 v248, v248, v3
    v_mul_f32 v249, v249, v3
    v_mul_f32 v250, v250, v3
    v_mul_f32 v251, v251, v3
    v_mul_f32 v252, v252, v3
    v_mul_f32 v253, v253, v3
    v_mul_f32 v254, v254, v3
    v_mul_f32 v255, v255, v3
    s_mov_b32 s98, 0
    s_nop 7
    s_branch L_rs_a0_back
L_raise1:
    s_nop 7
    v_mov_b32 v6, v5
    v_nop
    v_nop
    v_permlane32_swap_b32 v5, v6
    v_max_f32 v5, v5, v6
    v_max_f32 v5, 0, v5
    v_sub_f32 v64, v64, v5
    v_sub_f32 v65, v65, v5
    v_sub_f32 v66, v66, v5
    v_sub_f32 v67, v67, v5
    v_sub_f32 v68, v68, v5
    v_sub_f32 v69, v69, v5
    v_sub_f32 v70, v70, v5
    v_sub_f32 v71, v71, v5
    v_sub_f32 v72, v72, v5
    v_sub_f32 v73, v73, v5
    v_sub_f32 v74, v74, v5
    v_sub_f32 v75, v75, v5
    v_sub_f32 v76, v76, v5
    v_sub_f32 v77, v77, v5
    v_sub_f32 v78, v78, v5
    v_sub_f32 v79, v79, v5
    v_sub_f32 v80, v80, v5
    v_sub_f32 v81, v81, v5
    v_sub_f32 v82, v82, v5
    v_sub_f32 v83, v83, v5
    v_sub_f32 v84, v84, v5
    v_sub_f32 v85, v85, v5
    v_sub_f32 v86, v86, v5
    v_sub_f32 v87, v87, v5
    v_sub_f32 v88, v88, v5
    v_sub_f32 v89, v89, v5
    v_sub_f32 v90, v90, v5
    v_sub_f32 v91, v91, v5
    v_sub_f32 v92, v92, v5
    v_sub_f32 v93, v93, v5
    v_sub_f32 v94, v94, v5
    v_sub_f32 v95, v95, v5
    v_sub_f32 v96, v96, v5
    v_sub_f32 v97, v97, v5
    v_sub_f32 v98, v98, v5
    v_sub_f32 v99, v99, v5
    v_sub_f32 v100, v100, v5
    v_sub_f32 v101, v101, v5
    v_sub_f32 v102, v102, v5
    v_sub_f32 v103, v103, v5
    v_sub_f32 v104, v104, v5
    v_sub_f32 v105, v105, v5
    v_sub_f32 v106, v106, v5
    v_sub_f32 v107, v107, v5
    v_sub_f32 v108, v108, v5
    v_sub_f32 v109, v109, v5
    v_sub_f32 v110, v110, v5
    v_sub_f32 v111, v111, v5
    v_sub_f32 v112, v112, v5
    v_sub_f32 v113, v113, v5
    v_sub_f32 v114, v114, v5
    v_sub_f32 v115, v115, v5
    v_sub_f32 v116, v116, v5
    v_sub_f32 v117, v117, v5
    v_sub_f32 v118, v118, v5
    v_sub_f32 v119, v119, v5
    v_sub_f32 v120, v120, v5
    v_sub_f32 v121, v121, v5
    v_sub_f32 v122, v122, v5
    v_sub_f32 v123, v123, v5
    v_sub_f32 v124, v124, v5
    v_sub_f32 v125, v125, v5
    v_sub_f32 v126, v126, v5
    v_sub_f32 v127, v127, v5
    v_sub_f32 v176, v176, v5
    v_sub_f32 v177, v177, v5
    v_sub_f32 v178, v178, v5
    v_sub_f32 v179, v179, v5
    v_sub_f32 v180, v180, v5
    v_sub_f32 v181, v181, v5
    v_sub_f32 v182, v182, v5
    v_sub_f32 v183, v183, v5
    v_sub_f32 v184, v184, v5
    v_sub_f32 v185, v185, v5
    v_sub_f32 v186, v186, v5
    v_sub_f32 v187, v187, v5
    v_sub_f32 v188, v188, v5
    v_sub_f32 v189, v189, v5
    v_sub_f32 v190, v190, v5
    v_sub_f32 v191, v191, v5
    v_sub_f32 v3, 0, v5
    v_exp_f32 v3, v3
    s_nop 1
    v_mul_f32 v2, v2, v3
    v_mul_f32 v9, v9, v3
    v_mul_f32 v10, v10, v3
    v_mul_f32 v11, v11, v3
    s_mov_b32 s98, 1
    s_nop 7
    s_branch L_raise1_back
L_rs_a1:
    s_nop 15
    v_mul_f32 v192, v192, v3
    v_mul_f32 v193, v193, v3
    v_mul_f32 v194, v194, v3
    v_mul_f32 v195, v195, v3
    v_mul_f32 v196, v196, v3
    v_mul_f32 v197, v197, v3
    v_mul_f32 v198, v198, v3
    v_mul_f32 v199, v199, v3
    v_mul_f32 v200, v200, v3
    v_mul_f32 v201, v201, v3
    v_mul_f32 v202, v202, v3
    v_mul_f32 v203, v203, v3
    v_mul_f32 v204, v204, v3
    v_mul_f32 v205, v205, v3
    v_mul_f32 v206, v206, v3
    v_mul_f32 v207, v207, v3
    v_mul_f32 v208, v208, v3
    v_mul_f32 v209, v209, v3
    v_mul_f32 v210, v210, v3
    v_mul_f32 v211, v211, v3
    v_mul_f32 v212, v212, v3
    v_mul_f32 v213, v213, v3
    v_mul_f32 v214, v214, v3
    v_mul_f32 v215, v215, v3
    v_mul_f32 v216, v216, v3
    v_mul_f32 v217, v217, v3
    v_mul_f32 v218, v218, v3
    v_mul_f32 v219, v219, v3
    v_mul_f32 v220, v220, v3
    v_mul_f32 v221, v221, v3
    v_mul_f32 v222, v222, v3
    v_mul_f32 v223, v223, v3
    v_mul_f32 v224, v224, v3
    v_mul_f32 v225, v225, v3
    v_mul_f32 v226, v226, v3
    v_mul_f32 v227, v227, v3
    v_mul_f32 v228, v228, v3
    v_mul_f32 v229, v229, v3
    v_mul_f32 v230, v230, v3
    v_mul_f32 v231, v231, v3
    v_mul_f32 v232, v232, v3
    v_mul_f32 v233, v233, v3
    v_mul_f32 v234, v234, v3
    v_mul_f32 v235, v235, v3
    v_mul_f32 v236, v236, v3
    v_mul_f32 v237, v237, v3
    v_mul_f32 v238, v238, v3
    v_mul_f32 v239, v239, v3
    v_mul_f32 v240, v240, v3
    v_mul_f32 v241, v241, v3
    v_mul_f32 v242, v242, v3
    v_mul_f32 v243, v243, v3
    v_mul_f32 v244, v244, v3
    v_mul_f32 v245, v245, v3
    v_mul_f32 v246, v246, v3
    v_mul_f32 v247, v247, v3
    v_mul_f32 v248, v248, v3
    v_mul_f32 v249, v249, v3
    v_mul_f32 v250, v250, v3
    v_mul_f32 v251, v251, v3
    v_mul_f32 v252, v252, v3
    v_mul_f32 v253, v253, v3
    v_mul_f32 v254, v254, v3
    v_mul_f32 v255, v255, v3
    s_mov_b32 s98, 0
    s_nop 7
    s_branch L_rs_a1_back
L_raise2:
    s_nop 7
    v_mov_b32 v6, v5
    v_nop
    v_nop
    v_permlane32_swap_b32 v5, v6
    v_max_f32 v5, v5, v6
    v_max_f32 v5, 0, v5
    v_sub_f32 v64, v64, v5
    v_sub_f32 v65, v65, v5
    v_sub_f32 v66, v66, v5
    v_sub_f32 v67, v67, v5
    v_sub_f32 v68, v68, v5
    v_sub_f32 v69, v69, v5
    v_sub_f32 v70, v70, v5
    v_sub_f32 v71, v71, v5
    v_sub_f32 v72, v72, v5
    v_sub_f32 v73, v73, v5
    v_sub_f32 v74, v74, v5
    v_sub_f32 v75, v75, v5
    v_sub_f32 v76, v76, v5
    v_sub_f32 v77, v77, v5
    v_sub_f32 v78, v78, v5
    v_sub_f32 v79, v79, v5
    v_sub_f32 v80, v80, v5
    v_sub_f32 v81, v81, v5
    v_sub_f32 v82, v82, v5
    v_sub_f32 v83, v83, v5
    v_sub_f32 v84, v84, v5
    v_sub_f32 v85, v85, v5
    v_sub_f32 v86, v86, v5
    v_sub_f32 v87, v87, v5
    v_sub_f32 v88, v88, v5
    v_sub_f32 v89, v89, v5
    v_sub_f32 v90, v90, v5
    v_sub_f32 v91, v91, v5
    v_sub_f32 v92, v92, v5
    v_sub_f32 v93, v93, v5
    v_sub_f32 v94, v94, v5
    v_sub_f32 v95, v95, v5
    v_sub_f32 v96, v96, v5
    v_sub_f32 v97, v97, v5
    v_sub_f32 v98, v98, v5
    v_sub_f32 v99, v99, v5
    v_sub_f32 v100, v100, v5
    v_sub_f32 v101, v101, v5
    v_sub_f32 v102, v102, v5
    v_sub_f32 v103, v103, v5
    v_sub_f32 v104, v104, v5
    v_sub_f32 v105, v105, v5
    v_sub_f32 v106, v106, v5
    v_sub_f32 v107, v107, v5
    v_sub_f32 v108, v108, v5
    v_sub_f32 v109, v109, v5
    v_sub_f32 v110, v110, v5
    v_sub_f32 v111, v111, v5
    v_sub_f32 v112, v112, v5
    v_sub_f32 v113, v113, v5
    v_sub_f32 v114, v114, v5
    v_sub_f32 v115, v115, v5
    v_sub_f32 v116, v116, v5
    v_sub_f32 v117, v117, v5
    v_sub_f32 v118, v118, v5
    v_sub_f32 v119, v119, v5
    v_sub_f32 v120, v120, v5
    v_sub_f32 v121, v121, v5
    v_sub_f32 v122, v122, v5
    v_sub_f32 v123, v123, v5
    v_sub_f32 v124, v124, v5
    v_sub_f32 v125, v125, v5
    v_sub_f32 v126, v126, v5
    v_sub_f32 v127, v127, v5
    v_sub_f32 v176, v176, v5
    v_sub_f32 v177, v177, v5
    v_sub_f32 v178, v178, v5
    v_sub_f32 v179, v179, v5
    v_sub_f32 v180, v180, v5
    v_sub_f32 v181, v181, v5
    v_sub_f32 v182, v182, v5
    v_sub_f32 v183, v183, v5
    v_sub_f32 v184, v184, v5
    v_sub_f32 v185, v185, v5
    v_sub_f32 v186, v186, v5
    v_sub_f32 v187, v187, v5
    v_sub_f32 v188, v188, v5
    v_sub_f32 v189, v189, v5
    v_sub_f32 v190, v190, v5
    v_sub_f32 v191, v191, v5
    v_sub_f32 v3, 0, v5
    v_exp_f32 v3, v3
    s_nop 1
    v_mul_f32 v2, v2, v3
    v_mul_f32 v9, v9, v3
    v_mul_f32 v10, v10, v3
    v_mul_f32 v11, v11, v3
    s_mov_b32 s98, 1
    s_nop 7
    s_branch L_raise2_back
L_rs_a2:
    s_nop 15
    v_mul_f32 v192, v192, v3
    v_mul_f32 v193, v193, v3
    v_mul_f32 v194, v194, v3
    v_mul_f32 v195, v195, v3
    v_mul_f32 v196, v196, v3
    v_mul_f32 v197, v197, v3
    v_mul_f32 v198, v198, v3
    v_mul_f32 v199, v199, v3
    v_mul_f32 v200, v200, v3
    v_mul_f32 v201, v201, v3
    v_mul_f32 v202, v202, v3
    v_mul_f32 v203, v203, v3
    v_mul_f32 v204, v204, v3
    v_mul_f32 v205, v205, v3
    v_mul_f32 v206, v206, v3
    v_mul_f32 v207, v207, v3
    v_mul_f32 v208, v208, v3
    v_mul_f32 v209, v209, v3
    v_mul_f32 v210, v210, v3
    v_mul_f32 v211, v211, v3
    v_mul_f32 v212, v212, v3
    v_mul_f32 v213, v213, v3
    v_mul_f32 v214, v214, v3
    v_mul_f32 v215, v215, v3
    v_mul_f32 v216, v216, v3
    v_mul_f32 v217, v217, v3
    v_mul_f32 v218, v218, v3
    v_mul_f32 v219, v219, v3
    v_mul_f32 v220, v220, v3
    v_mul_f32 v221, v221, v3
    v_mul_f32 v222, v222, v3
    v_mul_f32 v223, v223, v3
    v_mul_f32 v224, v224, v3
    v_mul_f32 v225, v225, v3
    v_mul_f32 v226, v226, v3
    v_mul_f32 v227, v227, v3
    v_mul_f32 v228, v228, v3
    v_mul_f32 v229, v229, v3
    v_mul_f32 v230, v230, v3
    v_mul_f32 v231, v231, v3
    v_mul_f32 v232, v232, v3
    v_mul_f32 v233, v233, v3
    v_mul_f32 v234, v234, v3
    v_mul_f32 v235, v235, v3
    v_mul_f32 v236, v236, v3
    v_mul_f32 v237, v237, v3
    v_mul_f32 v238, v238, v3
    v_mul_f32 v239, v239, v3
    v_mul_f32 v240, v240, v3
    v_mul_f32 v241, v241, v3
    v_mul_f32 v242, v242, v3
    v_mul_f32 v243, v243, v3
    v_mul_f32 v244, v244, v3
    v_mul_f32 v245, v245, v3
    v_mul_f32 v246, v246, v3
    v_mul_f32 v247, v247, v3
    v_mul_f32 v248, v248, v3
    v_mul_f32 v249, v249, v3
    v_mul_f32 v250, v250, v3
    v_mul_f32 v251, v251, v3
    v_mul_f32 v252, v252, v3
    v_mul_f32 v253, v253, v3
    v_mul_f32 v254, v254, v3
    v_mul_f32 v255, v255, v3
    s_mov_b32 s98, 0
    s_nop 7
    s_branch L_rs_a2_back
L_raise3:
    s_nop 7
    v_mov_b32 v6, v5
    v_nop
    v_nop
    v_permlane32_swap_b32 v5, v6
    v_max_f32 v5, v5, v6
    v_max_f32 v5, 0, v5
    v_sub_f32 v64, v64, v5
    v_sub_f32 v65, v65, v5
    v_sub_f32 v66, v66, v5
    v_sub_f32 v67, v67, v5
    v_sub_f32 v68, v68, v5
    v_sub_f32 v69, v69, v5
    v_sub_f32 v70, v70, v5
    v_sub_f32 v71, v71, v5
    v_sub_f32 v72, v72, v5
    v_sub_f32 v73, v73, v5
    v_sub_f32 v74, v74, v5
    v_sub_f32 v75, v75, v5
    v_sub_f32 v76, v76, v5
    v_sub_f32 v77, v77, v5
    v_sub_f32 v78, v78, v5
    v_sub_f32 v79, v79, v5
    v_sub_f32 v80, v80, v5
    v_sub_f32 v81, v81, v5
    v_sub_f32 v82, v82, v5
    v_sub_f32 v83, v83, v5
    v_sub_f32 v84, v84, v5
    v_sub_f32 v85, v85, v5
    v_sub_f32 v86, v86, v5
    v_sub_f32 v87, v87, v5
    v_sub_f32 v88, v88, v5
    v_sub_f32 v89, v89, v5
    v_sub_f32 v90, v90, v5
    v_sub_f32 v91, v91, v5
    v_sub_f32 v92, v92, v5
    v_sub_f32 v93, v93, v5
    v_sub_f32 v94, v94, v5
    v_sub_f32 v95, v95, v5
    v_sub_f32 v96, v96, v5
    v_sub_f32 v97, v97, v5
    v_sub_f32 v98, v98, v5
    v_sub_f32 v99, v99, v5
    v_sub_f32 v100, v100, v5
    v_sub_f32 v101, v101, v5
    v_sub_f32 v102, v102, v5
    v_sub_f32 v103, v103, v5
    v_sub_f32 v104, v104, v5
    v_sub_f32 v105, v105, v5
    v_sub_f32 v106, v106, v5
    v_sub_f32 v107, v107, v5
    v_sub_f32 v108, v108, v5
    v_sub_f32 v109, v109, v5
    v_sub_f32 v110, v110, v5
    v_sub_f32 v111, v111, v5
    v_sub_f32 v112, v112, v5
    v_sub_f32 v113, v113, v5
    v_sub_f32 v114, v114, v5
    v_sub_f32 v115, v115, v5
    v_sub_f32 v116, v116, v5
    v_sub_f32 v117, v117, v5
    v_sub_f32 v118, v118, v5
    v_sub_f32 v119, v119, v5
    v_sub_f32 v120, v120, v5
    v_sub_f32 v121, v121, v5
    v_sub_f32 v122, v122, v5
    v_sub_f32 v123, v123, v5
    v_sub_f32 v124, v124, v5
    v_sub_f32 v125, v125, v5
    v_sub_f32 v126, v126, v5
    v_sub_f32 v127, v127, v5
    v_sub_f32 v176, v176, v5
    v_sub_f32 v177, v177, v5
    v_sub_f32 v178, v178, v5
    v_sub_f32 v179, v179, v5
    v_sub_f32 v180, v180, v5
    v_sub_f32 v181, v181, v5
    v_sub_f32 v182, v182, v5
    v_sub_f32 v183, v183, v5
    v_sub_f32 v184, v184, v5
    v_sub_f32 v185, v185, v5
    v_sub_f32 v186, v186, v5
    v_sub_f32 v187, v187, v5
    v_sub_f32 v188, v188, v5
    v_sub_f32 v189, v189, v5
    v_sub_f32 v190, v190, v5
    v_sub_f32 v191, v191, v5
    v_sub_f32 v3, 0, v5
    v_exp_f32 v3, v3
    s_nop 1
    v_mul_f32 v2, v2, v3
    v_mul_f32 v9, v9, v3
    v_mul_f32 v10, v10, v3
    v_mul_f32 v11, v11, v3
    s_mov_b32 s98, 1
    s_nop 7
    s_branch L_raise3_back
L_rs_a3:
    s_nop 15
    v_mul_f32 v192, v192, v3
    v_mul_f32 v193, v193, v3
    v_mul_f32 v194, v194, v3
    v_mul_f32 v195, v195, v3
    v_mul_f32 v196, v196, v3
    v_mul_f32 v197, v197, v3
    v_mul_f32 v198, v198, v3
    v_mul_f32 v199, v199, v3
    v_mul_f32 v200, v200, v3
    v_mul_f32 v201, v201, v3
    v_mul_f32 v202, v202, v3
    v_mul_f32 v203, v203, v3
    v_mul_f32 v204, v204, v3
    v_mul_f32 v205, v205, v3
    v_mul_f32 v206, v206, v3
    v_mul_f32 v207, v207, v3
    v_mul_f32 v208, v208, v3
    v_mul_f32 v209, v209, v3
    v_mul_f32 v210, v210, v3
    v_mul_f32 v211, v211, v3
    v_mul_f32 v212, v212, v3
    v_mul_f32 v213, v213, v3
    v_mul_f32 v214, v214, v3
    v_mul_f32 v215, v215, v3
    v_mul_f32 v216, v216, v3
    v_mul_f32 v217, v217, v3
    v_mul_f32 v218, v218, v3
    v_mul_f32 v219, v219, v3
    v_mul_f32 v220, v220, v3
    v_mul_f32 v221, v221, v3
    v_mul_f32 v222, v222, v3
    v_mul_f32 v223, v223, v3
    v_mul_f32 v224, v224, v3
    v_mul_f32 v225, v225, v3
    v_mul_f32 v226, v226, v3
    v_mul_f32 v227, v227, v3
    v_mul_f32 v228, v228, v3
    v_mul_f32 v229, v229, v3
    v_mul_f32 v230, v230, v3
    v_mul_f32 v231, v231, v3
    v_mul_f32 v232, v232, v3
    v_mul_f32 v233, v233, v3
    v_mul_f32 v234, v234, v3
    v_mul_f32 v235, v235, v3
    v_mul_f32 v236, v236, v3
    v_mul_f32 v237, v237, v3
    v_mul_f32 v238, v238, v3
    v_mul_f32 v239, v239, v3
    v_mul_f32 v240, v240, v3
    v_mul_f32 v241, v241, v3
    v_mul_f32 v242, v242, v3
    v_mul_f32 v243, v243, v3
    v_mul_f32 v244, v244, v3
    v_mul_f32 v245, v245, v3
    v_mul_f32 v246, v246, v3
    v_mul_f32 v247, v247, v3
    v_mul_f32 v248, v248, v3
    v_mul_f32 v249, v249, v3
    v_mul_f32 v250, v250, v3
    v_mul_f32 v251, v251, v3
    v_mul_f32 v252, v252, v3
    v_mul_f32 v253, v253, v3
    v_mul_f32 v254, v254, v3
    v_mul_f32 v255, v255, v3
    s_mov_b32 s98, 0
    s_nop 7
    s_branch L_rs_a3_back
L_code_end:

.section .rodata,"a"
.p2align 6
.amdhsa_kernel standalone__mha_block_cached__near_ridge_kernel
  .amdhsa_next_free_vgpr 512
  .amdhsa_next_free_sgpr 102
  .amdhsa_accum_offset 256
  .amdhsa_group_segment_fixed_size 0
  .amdhsa_kernarg_size 64
  .amdhsa_user_sgpr_count 2
  .amdhsa_user_sgpr_kernarg_segment_ptr 1
  .amdhsa_system_sgpr_workgroup_id_x 1
  .amdhsa_float_denorm_mode_32 3
.end_amdhsa_kernel
```
